```python
import torch

def _softmax(x, axis=-1):
    return torch.softmax(x, dim=axis)
def _gelu(x):
    return torch.nn.functional.gelu(x, approximate="tanh")
def _silu(x):
    return torch.nn.functional.silu(x)
def _sigmoid(x):
    return torch.sigmoid(x)
def _layernorm(x, axis=-1, eps=1e-5):
    m = x.mean(dim=axis, keepdim=True)
    v = x.var(dim=axis, keepdim=True, unbiased=False)
    return (x - m) / torch.sqrt(v + eps)
def _scatter_add(tgt, idx, src, axis=0):
    return tgt.clone().index_add_(axis, idx, src)
def _segment_sum(src, seg, n):
    out = torch.zeros((n,) + src.shape[1:], dtype=src.dtype)
    return out.index_add_(0, seg, src)
def _pad(x, pw):
    flat = tuple(v for pair in reversed(pw) for v in pair)
    return torch.nn.functional.pad(x, flat)

kernel_name = 'concat_heads__ssm_conv_s5__mha_block__prompt'

def setup_inputs():

    _w = (lambda a: (lambda t: t.to(torch.bfloat16) if t.is_floating_point() else t)(torch.as_tensor(a)))
    def _A_setup():
        B, S, D = 1, 2048, 448
        P = D
        Lambda_re = -0.5 * (lambda _x: torch.exp(torch.as_tensor(_x)))((lambda *s: torch.randn(*s, dtype=torch.bfloat16) * 0.4)(P))
        Lambda_im = (lambda *s: torch.randn(*s, dtype=torch.bfloat16) * 0.8)(P) * 1.0
        B_re = (lambda *s: torch.randn(*s, dtype=torch.bfloat16) * 0.4)(P, D) * (D ** -0.5)
        B_im = (lambda *s: torch.randn(*s, dtype=torch.bfloat16) * 0.4)(P, D) * (D ** -0.5)
        C_re = (lambda *s: torch.randn(*s, dtype=torch.bfloat16) * 0.4)(D, P) * (P ** -0.5)
        C_im = (lambda *s: torch.randn(*s, dtype=torch.bfloat16) * 0.4)(D, P) * (P ** -0.5)
        log_dt = (lambda *s: torch.randn(*s, dtype=torch.bfloat16) * 0.4)(P) * 0.3 - 2.0
        Dskip = (lambda *s: torch.randn(*s, dtype=torch.bfloat16) * 0.05)(D)
        return {
            "x": _w((lambda *s: torch.randn(*s, dtype=torch.bfloat16) * 0.05)(B, S, D)),
            "Lambda_re": _w(Lambda_re),
            "Lambda_im": _w(Lambda_im),
            "B_re": _w(B_re),
            "B_im": _w(B_im),
            "C_re": _w(C_re),
            "C_im": _w(C_im),
            "log_dt": _w(log_dt),
            "Dskip": _w(Dskip),
        }
    _A_in = _A_setup()

    def _B_setup():
        B, S, D, H = 1, 2048, 448, 16
        return {
            "x": _w((lambda *s: torch.randn(*s, dtype=torch.bfloat16) * 0.2)(B, S, D)),
            "wqkv": _w((lambda *s: torch.randn(*s, dtype=torch.bfloat16) * 0.2)(D, 3 * D)),
            "wo": _w((lambda *s: torch.randn(*s, dtype=torch.bfloat16) * 0.05)(D, D)),
        }
    _B_in = _B_setup()

    return {
        "A_x": _A_in["x"],
        "A_Lambda_re": _A_in["Lambda_re"],
        "A_Lambda_im": _A_in["Lambda_im"],
        "A_B_re": _A_in["B_re"],
        "A_B_im": _A_in["B_im"],
        "A_C_re": _A_in["C_re"],
        "A_C_im": _A_in["C_im"],
        "A_log_dt": _A_in["log_dt"],
        "A_Dskip": _A_in["Dskip"],
        "B_x": _B_in["x"],
        "B_wqkv": _B_in["wqkv"],
        "B_wo": _B_in["wo"],
    }

def reference(A_x, A_Lambda_re, A_Lambda_im, A_B_re, A_B_im, A_C_re, A_C_im, A_log_dt, A_Dskip, B_x, B_wqkv, B_wo):
    def _A_ref(x, Lambda_re, Lambda_im, B_re, B_im, C_re, C_im, log_dt, Dskip):
        Bsz, L, H = x.shape
        Lam = Lambda_re + 1j * Lambda_im
        Bmat = B_re + 1j * B_im
        Cmat = C_re + 1j * C_im
        dt = torch.exp(log_dt)
        Lam_bar = torch.exp(dt * Lam)
        B_bar = ((Lam_bar - 1.0) / Lam)[:, None] * Bmat
        Bu = torch.einsum("bld,pd->blp", x + 0j, B_bar)
        h = torch.zeros_like(Bu[:, 0, :])
        hs = []
        for t in range(L):
            h = Lam_bar[None, :] * h + Bu[:, t, :]
            hs.append(h)
        hseq = torch.stack(hs, 1)
        y = 2.0 * torch.einsum("blp,dp->bld", hseq, Cmat).real + x * Dskip[None, None, :]
        return y

    def _B_ref(x, wqkv, wo):
        B, S, D = x.shape
        H = 16
        Dh = D // H
        qkv = (lambda x, *d: x.permute(*d))((x @ wqkv).reshape(B, S, 3, H, Dh), 2, 0, 3, 1, 4)
        q, k, v = qkv[0], qkv[1], qkv[2]
        scores = torch.einsum("bhqd,bhkd->bhqk", q, k) * (Dh ** -0.5)
        p = _softmax(scores, axis=-1)
        o = torch.einsum("bhqk,bhkd->bhqd", p, v)
        return (lambda x, *d: x.permute(*d))(o, 0, 2, 1, 3).reshape(B, S, D) @ wo

    a = _A_ref(A_x, A_Lambda_re, A_Lambda_im, A_B_re, A_B_im, A_C_re, A_C_im, A_log_dt, A_Dskip)
    b = _B_ref(B_x, B_wqkv, B_wo)
    return torch.concatenate([a, b], axis=-1)
```

```asm
; @launch kernel=k1_kernel grid=(240,1,1) block=(512,1,1) lds=147456
; @launch kernel=k2_kernel grid=(256,1,1) block=(512,1,1) lds=141568
; @launch kernel=k3_kernel grid=(224,1,1) block=(512,1,1) lds=147456
.amdgcn_target "amdgcn-amd-amdhsa--gfx950"
.text
.globl k1_kernel
.p2align 8
.type k1_kernel,@function
k1_kernel:
    s_cmp_ge_u32 s2, 240
    s_cbranch_scc1 k1_exit
    s_load_dwordx16 s[16:31], s[0:1], 0
    s_load_dwordx8 s[32:39], s[0:1], 64
    s_load_dwordx2 s[40:41], s[0:1], 96
    s_load_dwordx2 s[42:43], s[0:1], 112
    v_lshrrev_b32 v1, 6, v0
    v_and_b32 v0, 63, v0
    s_nop 0
    v_readfirstlane_b32 s3, v1
    s_and_b32 s4, s2, 7
    s_lshr_b32 s5, s2, 3
    s_and_b32 s6, s5, 1
    s_lshl_b32 s8, s4, 1
    s_add_u32 s6, s6, s8
    s_lshr_b32 s7, s5, 1
    s_and_b32 s9, s3, 3
    s_lshr_b32 s10, s3, 2
    v_and_b32 v1, 31, v0
    v_lshrrev_b32 v2, 5, v0
    v_lshrrev_b32 v3, 3, v0
    v_and_b32 v4, 7, v0
    v_lshrrev_b32 v5, 4, v0
    s_lshl_b32 s11, s9, 5
    v_add_u32 v6, s11, v1
    v_lshrrev_b32 v7, 1, v1
    v_and_b32 v7, 7, v7
    v_xor_b32 v7, v7, v2
    v_lshlrev_b32 v7, 4, v7
    v_lshl_add_u32 v8, v6, 7, v7
    v_xor_b32 v9, 32, v8
    v_xor_b32 v10, 64, v8
    v_xor_b32 v11, 0x60, v8
    v_xor_b32 v12, v4, v5
    v_lshlrev_b32 v12, 4, v12
    v_xor_b32 v13, 64, v12
    s_waitcnt lgkmcnt(0)
    s_cmp_ge_u32 s7, 8
    s_cbranch_scc1 k1_u
    s_mov_b32 s44, s34
    s_mov_b32 s45, s35
    s_mov_b32 s46, 0x1c0000
    s_mov_b32 s47, 0x20000
    s_mov_b32 s48, s36
    s_mov_b32 s49, s37
    s_mov_b32 s50, 0x126000
    s_mov_b32 s51, 0x20000
    s_mov_b32 s56, s42
    s_mov_b32 s57, s43
    s_mov_b32 s58, 0x600000
    s_mov_b32 s59, 0x20000
    s_lshl_b32 s11, s6, 7
    s_lshl_b32 s12, s3, 4
    s_add_u32 s11, s11, s12
    v_add_u32 v6, s11, v3
    v_mul_u32_u24 v6, 896, v6
    v_add_u32 v14, v6, v12
    v_add_u32 v15, v6, v13
    v_add_u32 v15, 7168, v15
    s_lshl_b32 s11, s7, 1
    s_add_u32 s11, s11, s10
    s_mul_i32 s12, s11, 168
    s_and_b32 s13, s12, 15
    s_and_b32 s12, s12, 0xfffffff0
    s_lshl_b32 s14, s9, 4
    v_add_u32 v6, s14, v5
    v_mul_u32_u24 v6, 2688, v6
    v_and_b32 v7, 15, v0
    v_lshlrev_b32 v17, 2, v5
    v_xor_b32 v7, v7, v17
    v_cmp_gt_u32 vcc, 11, v7
    v_lshlrev_b32 v7, 4, v7
    v_add3_u32 v16, v6, v7, s12
    s_mov_b64 s[72:73], vcc
    v_and_b32 v6, 15, v0
    v_lshrrev_b32 v7, 2, v6
    v_and_b32 v17, 3, v0
    v_lshlrev_b32 v17, 3, v17
    v_and_b32 v24, 1, v5
    v_lshl_add_u32 v17, v24, 5, v17
    v_add_u32 v17, s13, v17
    v_lshrrev_b32 v24, 1, v5
    v_lshl_add_u32 v24, v24, 3, v7
    v_lshlrev_b32 v24, 8, v24
    s_lshl_b32 s14, s10, 14
    s_add_u32 s14, s14, 49152
    v_add_u32 v24, s14, v24
    v_lshlrev_b32 v7, 6, v7
    v_add_u32 v6, 0, v17
    v_xor_b32 v6, v6, v7
    v_add_u32 v18, v6, v24
    v_add_u32 v21, 0x10000, v18
    v_add_u32 v6, 56, v17
    v_xor_b32 v6, v6, v7
    v_add_u32 v19, v6, v24
    v_add_u32 v22, 0x10000, v19
    v_add_u32 v6, 112, v17
    v_xor_b32 v6, v6, v7
    v_add_u32 v20, v6, v24
    v_add_u32 v23, 0x10000, v20
    s_lshl_b32 s74, s3, 11
    s_lshl_b32 s75, s9, 12
    s_add_u32 s75, s75, s14
    s_mul_i32 s77, s7, 6
    s_mul_i32 s78, s10, 3
    s_add_u32 s77, s77, s78
    s_cmp_ge_u32 s77, 32
    s_cbranch_scc1 k1_vvv
    s_cmp_eq_u32 s77, 30
    s_cbranch_scc1 k1_nnv
k1_nnn:
    s_add_u32 m0, s74, 0
    s_mov_b32 s76, 0
    buffer_load_dwordx4 v14, s[44:47], s76 offen lds
    s_mov_b64 exec, s[72:73]
    s_add_u32 m0, s75, 0
    s_mov_b32 s76, 0
    buffer_load_dwordx4 v16, s[48:51], s76 offen lds
    s_mov_b64 exec, -1
    s_mov_b64 exec, s[72:73]
    s_add_u32 m0, s75, 1024
    s_mov_b32 s76, 10752
    buffer_load_dwordx4 v16, s[48:51], s76 offen lds
    s_mov_b64 exec, -1
    s_add_u32 m0, s74, 1024
    s_mov_b32 s76, 0
    buffer_load_dwordx4 v15, s[44:47], s76 offen lds
    s_mov_b64 exec, s[72:73]
    s_add_u32 m0, s75, 2048
    s_mov_b32 s76, 21504
    buffer_load_dwordx4 v16, s[48:51], s76 offen lds
    s_mov_b64 exec, -1
    s_mov_b64 exec, s[72:73]
    s_add_u32 m0, s75, 3072
    s_mov_b32 s76, 32256
    buffer_load_dwordx4 v16, s[48:51], s76 offen lds
    s_mov_b64 exec, -1
    s_add_u32 m0, s74, 16384
    s_mov_b32 s76, 128
    buffer_load_dwordx4 v14, s[44:47], s76 offen lds
    s_mov_b64 exec, s[72:73]
    s_add_u32 m0, s75, 32768
    s_mov_b32 s76, 172032
    buffer_load_dwordx4 v16, s[48:51], s76 offen lds
    s_mov_b64 exec, -1
    s_mov_b64 exec, s[72:73]
    s_add_u32 m0, s75, 33792
    s_mov_b32 s76, 182784
    buffer_load_dwordx4 v16, s[48:51], s76 offen lds
    s_mov_b64 exec, -1
    s_add_u32 m0, s74, 17408
    s_mov_b32 s76, 128
    buffer_load_dwordx4 v15, s[44:47], s76 offen lds
    s_mov_b64 exec, s[72:73]
    s_add_u32 m0, s75, 34816
    s_mov_b32 s76, 193536
    buffer_load_dwordx4 v16, s[48:51], s76 offen lds
    s_mov_b64 exec, -1
    s_mov_b64 exec, s[72:73]
    s_add_u32 m0, s75, 35840
    s_mov_b32 s76, 204288
    buffer_load_dwordx4 v16, s[48:51], s76 offen lds
    s_mov_b64 exec, -1
    s_lshl_b32 s80, s7, 4
    s_add_u32 s80, s80, s6
    s_cmp_ge_u32 s3, 4
    s_cbranch_scc1 pfh1
    s_mul_i32 s81, s80, 112
    s_mov_b32 s82, s3
    s_mul_i32 s82, s82, 28
    s_add_u32 s81, s81, s82
    v_add_u32 v224, s81, v0
    v_lshlrev_b32 v224, 7, v224
    v_cmp_gt_u32 vcc, 28, v0
    v_mov_b32 v225, 0x7fffff00
    s_nop 0
    v_cndmask_b32 v224, v225, v224, vcc
    buffer_load_dword v224, v224, s[44:47], 0 offen
    s_branch pfe1
pfh1:
    s_mul_i32 s81, s80, 74
    s_sub_u32 s82, s3, 4
    s_mul_i32 s82, s82, 19
    s_add_u32 s81, s81, s82
    v_add_u32 v224, s81, v0
    v_lshlrev_b32 v224, 7, v224
    v_cmp_gt_u32 vcc, 19, v0
    v_mov_b32 v225, 0x7fffff00
    s_nop 0
    v_cndmask_b32 v224, v225, v224, vcc
    buffer_load_dword v224, v224, s[48:51], 0 offen
pfe1:
    s_waitcnt vmcnt(7) lgkmcnt(0)
    s_barrier
    ds_read_b128 v[80:83], v8 offset:0
    ds_read_b64_tr_b16 v[84:85], v18 offset:0
    ds_read_b64_tr_b16 v[86:87], v18 offset:1024
    ds_read_b64_tr_b16 v[88:89], v19 offset:0
    ds_read_b64_tr_b16 v[90:91], v19 offset:1024
    ds_read_b64_tr_b16 v[92:93], v20 offset:0
    ds_read_b64_tr_b16 v[94:95], v20 offset:1024
    s_add_u32 m0, s74, 32768
    s_mov_b32 s76, 256
    buffer_load_dwordx4 v14, s[44:47], s76 offen lds
    s_mov_b64 exec, s[72:73]
    s_add_u32 m0, s75, 65536
    s_mov_b32 s76, 344064
    buffer_load_dwordx4 v16, s[48:51], s76 offen lds
    s_mov_b64 exec, -1
    ds_read_b128 v[96:99], v9 offset:0
    ds_read_b64_tr_b16 v[100:101], v18 offset:4096
    ds_read_b64_tr_b16 v[102:103], v18 offset:5120
    ds_read_b64_tr_b16 v[104:105], v19 offset:4096
    ds_read_b64_tr_b16 v[106:107], v19 offset:5120
    ds_read_b64_tr_b16 v[108:109], v20 offset:4096
    ds_read_b64_tr_b16 v[110:111], v20 offset:5120
    s_mov_b64 exec, s[72:73]
    s_add_u32 m0, s75, 66560
    s_mov_b32 s76, 354816
    buffer_load_dwordx4 v16, s[48:51], s76 offen lds
    s_mov_b64 exec, -1
    ds_read_b128 v[112:115], v10 offset:0
    ds_read_b64_tr_b16 v[116:117], v18 offset:8192
    ds_read_b64_tr_b16 v[118:119], v18 offset:9216
    ds_read_b64_tr_b16 v[120:121], v19 offset:8192
    ds_read_b64_tr_b16 v[122:123], v19 offset:9216
    ds_read_b64_tr_b16 v[124:125], v20 offset:8192
    ds_read_b64_tr_b16 v[126:127], v20 offset:9216
    s_add_u32 m0, s74, 33792
    s_mov_b32 s76, 256
    buffer_load_dwordx4 v15, s[44:47], s76 offen lds
    s_mov_b64 exec, s[72:73]
    s_add_u32 m0, s75, 67584
    s_mov_b32 s76, 365568
    buffer_load_dwordx4 v16, s[48:51], s76 offen lds
    s_mov_b64 exec, -1
    ds_read_b128 v[128:131], v11 offset:0
    ds_read_b64_tr_b16 v[132:133], v18 offset:12288
    ds_read_b64_tr_b16 v[134:135], v18 offset:13312
    ds_read_b64_tr_b16 v[136:137], v19 offset:12288
    ds_read_b64_tr_b16 v[138:139], v19 offset:13312
    ds_read_b64_tr_b16 v[140:141], v20 offset:12288
    ds_read_b64_tr_b16 v[142:143], v20 offset:13312
    s_mov_b64 exec, s[72:73]
    s_add_u32 m0, s75, 68608
    s_mov_b32 s76, 376320
    buffer_load_dwordx4 v16, s[48:51], s76 offen lds
    s_mov_b64 exec, -1
    s_waitcnt vmcnt(7) lgkmcnt(0)
    s_barrier
    ds_read_b128 v[144:147], v8 offset:16384
    ds_read_b64_tr_b16 v[148:149], v18 offset:32768
    ds_read_b64_tr_b16 v[150:151], v18 offset:33792
    ds_read_b64_tr_b16 v[152:153], v19 offset:32768
    ds_read_b64_tr_b16 v[154:155], v19 offset:33792
    ds_read_b64_tr_b16 v[156:157], v20 offset:32768
    ds_read_b64_tr_b16 v[158:159], v20 offset:33792
    v_mfma_f32_32x32x16_bf16 v[32:47], v[84:87], v[80:83], 0
    v_mfma_f32_32x32x16_bf16 v[48:63], v[88:91], v[80:83], 0
    v_mfma_f32_32x32x16_bf16 v[64:79], v[92:95], v[80:83], 0
    s_add_u32 m0, s74, 0
    s_mov_b32 s76, 384
    buffer_load_dwordx4 v14, s[44:47], s76 offen lds
    s_mov_b64 exec, s[72:73]
    s_add_u32 m0, s75, 0
    s_mov_b32 s76, 516096
    buffer_load_dwordx4 v16, s[48:51], s76 offen lds
    s_mov_b64 exec, -1
    ds_read_b128 v[160:163], v9 offset:16384
    ds_read_b64_tr_b16 v[164:165], v18 offset:36864
    ds_read_b64_tr_b16 v[166:167], v18 offset:37888
    ds_read_b64_tr_b16 v[168:169], v19 offset:36864
    ds_read_b64_tr_b16 v[170:171], v19 offset:37888
    ds_read_b64_tr_b16 v[172:173], v20 offset:36864
    ds_read_b64_tr_b16 v[174:175], v20 offset:37888
    v_mfma_f32_32x32x16_bf16 v[32:47], v[100:103], v[96:99], v[32:47]
    v_mfma_f32_32x32x16_bf16 v[48:63], v[104:107], v[96:99], v[48:63]
    v_mfma_f32_32x32x16_bf16 v[64:79], v[108:111], v[96:99], v[64:79]
    s_mov_b64 exec, s[72:73]
    s_add_u32 m0, s75, 1024
    s_mov_b32 s76, 526848
    buffer_load_dwordx4 v16, s[48:51], s76 offen lds
    s_mov_b64 exec, -1
    ds_read_b128 v[176:179], v10 offset:16384
    ds_read_b64_tr_b16 v[180:181], v18 offset:40960
    ds_read_b64_tr_b16 v[182:183], v18 offset:41984
    ds_read_b64_tr_b16 v[184:185], v19 offset:40960
    ds_read_b64_tr_b16 v[186:187], v19 offset:41984
    ds_read_b64_tr_b16 v[188:189], v20 offset:40960
    ds_read_b64_tr_b16 v[190:191], v20 offset:41984
    v_mfma_f32_32x32x16_bf16 v[32:47], v[116:119], v[112:115], v[32:47]
    v_mfma_f32_32x32x16_bf16 v[48:63], v[120:123], v[112:115], v[48:63]
    v_mfma_f32_32x32x16_bf16 v[64:79], v[124:127], v[112:115], v[64:79]
    s_add_u32 m0, s74, 1024
    s_mov_b32 s76, 384
    buffer_load_dwordx4 v15, s[44:47], s76 offen lds
    s_mov_b64 exec, s[72:73]
    s_add_u32 m0, s75, 2048
    s_mov_b32 s76, 537600
    buffer_load_dwordx4 v16, s[48:51], s76 offen lds
    s_mov_b64 exec, -1
    ds_read_b128 v[192:195], v11 offset:16384
    ds_read_b64_tr_b16 v[196:197], v18 offset:45056
    ds_read_b64_tr_b16 v[198:199], v18 offset:46080
    ds_read_b64_tr_b16 v[200:201], v19 offset:45056
    ds_read_b64_tr_b16 v[202:203], v19 offset:46080
    ds_read_b64_tr_b16 v[204:205], v20 offset:45056
    ds_read_b64_tr_b16 v[206:207], v20 offset:46080
    v_mfma_f32_32x32x16_bf16 v[32:47], v[132:135], v[128:131], v[32:47]
    v_mfma_f32_32x32x16_bf16 v[48:63], v[136:139], v[128:131], v[48:63]
    v_mfma_f32_32x32x16_bf16 v[64:79], v[140:143], v[128:131], v[64:79]
    s_mov_b64 exec, s[72:73]
    s_add_u32 m0, s75, 3072
    s_mov_b32 s76, 548352
    buffer_load_dwordx4 v16, s[48:51], s76 offen lds
    s_mov_b64 exec, -1
    s_waitcnt vmcnt(6) lgkmcnt(0)
    s_barrier
    ds_read_b128 v[80:83], v8 offset:32768
    ds_read_b64_tr_b16 v[84:85], v21 offset:0
    ds_read_b64_tr_b16 v[86:87], v21 offset:1024
    ds_read_b64_tr_b16 v[88:89], v22 offset:0
    ds_read_b64_tr_b16 v[90:91], v22 offset:1024
    ds_read_b64_tr_b16 v[92:93], v23 offset:0
    ds_read_b64_tr_b16 v[94:95], v23 offset:1024
    v_mfma_f32_32x32x16_bf16 v[32:47], v[148:151], v[144:147], v[32:47]
    v_mfma_f32_32x32x16_bf16 v[48:63], v[152:155], v[144:147], v[48:63]
    v_mfma_f32_32x32x16_bf16 v[64:79], v[156:159], v[144:147], v[64:79]
    s_add_u32 m0, s74, 16384
    s_mov_b32 s76, 512
    buffer_load_dwordx4 v14, s[44:47], s76 offen lds
    s_mov_b64 exec, s[72:73]
    s_add_u32 m0, s75, 32768
    s_mov_b32 s76, 688128
    buffer_load_dwordx4 v16, s[48:51], s76 offen lds
    s_mov_b64 exec, -1
    ds_read_b128 v[96:99], v9 offset:32768
    ds_read_b64_tr_b16 v[100:101], v21 offset:4096
    ds_read_b64_tr_b16 v[102:103], v21 offset:5120
    ds_read_b64_tr_b16 v[104:105], v22 offset:4096
    ds_read_b64_tr_b16 v[106:107], v22 offset:5120
    ds_read_b64_tr_b16 v[108:109], v23 offset:4096
    ds_read_b64_tr_b16 v[110:111], v23 offset:5120
    v_mfma_f32_32x32x16_bf16 v[32:47], v[164:167], v[160:163], v[32:47]
    v_mfma_f32_32x32x16_bf16 v[48:63], v[168:171], v[160:163], v[48:63]
    v_mfma_f32_32x32x16_bf16 v[64:79], v[172:175], v[160:163], v[64:79]
    s_mov_b64 exec, s[72:73]
    s_add_u32 m0, s75, 33792
    s_mov_b32 s76, 698880
    buffer_load_dwordx4 v16, s[48:51], s76 offen lds
    s_mov_b64 exec, -1
    ds_read_b128 v[112:115], v10 offset:32768
    ds_read_b64_tr_b16 v[116:117], v21 offset:8192
    ds_read_b64_tr_b16 v[118:119], v21 offset:9216
    ds_read_b64_tr_b16 v[120:121], v22 offset:8192
    ds_read_b64_tr_b16 v[122:123], v22 offset:9216
    ds_read_b64_tr_b16 v[124:125], v23 offset:8192
    ds_read_b64_tr_b16 v[126:127], v23 offset:9216
    v_mfma_f32_32x32x16_bf16 v[32:47], v[180:183], v[176:179], v[32:47]
    v_mfma_f32_32x32x16_bf16 v[48:63], v[184:187], v[176:179], v[48:63]
    v_mfma_f32_32x32x16_bf16 v[64:79], v[188:191], v[176:179], v[64:79]
    s_add_u32 m0, s74, 17408
    s_mov_b32 s76, 512
    buffer_load_dwordx4 v15, s[44:47], s76 offen lds
    s_mov_b64 exec, s[72:73]
    s_add_u32 m0, s75, 34816
    s_mov_b32 s76, 709632
    buffer_load_dwordx4 v16, s[48:51], s76 offen lds
    s_mov_b64 exec, -1
    ds_read_b128 v[128:131], v11 offset:32768
    ds_read_b64_tr_b16 v[132:133], v21 offset:12288
    ds_read_b64_tr_b16 v[134:135], v21 offset:13312
    ds_read_b64_tr_b16 v[136:137], v22 offset:12288
    ds_read_b64_tr_b16 v[138:139], v22 offset:13312
    ds_read_b64_tr_b16 v[140:141], v23 offset:12288
    ds_read_b64_tr_b16 v[142:143], v23 offset:13312
    v_mfma_f32_32x32x16_bf16 v[32:47], v[196:199], v[192:195], v[32:47]
    v_mfma_f32_32x32x16_bf16 v[48:63], v[200:203], v[192:195], v[48:63]
    v_mfma_f32_32x32x16_bf16 v[64:79], v[204:207], v[192:195], v[64:79]
    s_mov_b64 exec, s[72:73]
    s_add_u32 m0, s75, 35840
    s_mov_b32 s76, 720384
    buffer_load_dwordx4 v16, s[48:51], s76 offen lds
    s_mov_b64 exec, -1
    s_waitcnt vmcnt(6) lgkmcnt(0)
    s_barrier
    ds_read_b128 v[144:147], v8 offset:0
    ds_read_b64_tr_b16 v[148:149], v18 offset:0
    ds_read_b64_tr_b16 v[150:151], v18 offset:1024
    ds_read_b64_tr_b16 v[152:153], v19 offset:0
    ds_read_b64_tr_b16 v[154:155], v19 offset:1024
    ds_read_b64_tr_b16 v[156:157], v20 offset:0
    ds_read_b64_tr_b16 v[158:159], v20 offset:1024
    v_mfma_f32_32x32x16_bf16 v[32:47], v[84:87], v[80:83], v[32:47]
    v_mfma_f32_32x32x16_bf16 v[48:63], v[88:91], v[80:83], v[48:63]
    v_mfma_f32_32x32x16_bf16 v[64:79], v[92:95], v[80:83], v[64:79]
    s_add_u32 m0, s74, 32768
    s_mov_b32 s76, 640
    buffer_load_dwordx4 v14, s[44:47], s76 offen lds
    s_mov_b64 exec, s[72:73]
    s_add_u32 m0, s75, 65536
    s_mov_b32 s76, 860160
    buffer_load_dwordx4 v16, s[48:51], s76 offen lds
    s_mov_b64 exec, -1
    ds_read_b128 v[160:163], v9 offset:0
    ds_read_b64_tr_b16 v[164:165], v18 offset:4096
    ds_read_b64_tr_b16 v[166:167], v18 offset:5120
    ds_read_b64_tr_b16 v[168:169], v19 offset:4096
    ds_read_b64_tr_b16 v[170:171], v19 offset:5120
    ds_read_b64_tr_b16 v[172:173], v20 offset:4096
    ds_read_b64_tr_b16 v[174:175], v20 offset:5120
    v_mfma_f32_32x32x16_bf16 v[32:47], v[100:103], v[96:99], v[32:47]
    v_mfma_f32_32x32x16_bf16 v[48:63], v[104:107], v[96:99], v[48:63]
    v_mfma_f32_32x32x16_bf16 v[64:79], v[108:111], v[96:99], v[64:79]
    s_mov_b64 exec, s[72:73]
    s_add_u32 m0, s75, 66560
    s_mov_b32 s76, 870912
    buffer_load_dwordx4 v16, s[48:51], s76 offen lds
    s_mov_b64 exec, -1
    ds_read_b128 v[176:179], v10 offset:0
    ds_read_b64_tr_b16 v[180:181], v18 offset:8192
    ds_read_b64_tr_b16 v[182:183], v18 offset:9216
    ds_read_b64_tr_b16 v[184:185], v19 offset:8192
    ds_read_b64_tr_b16 v[186:187], v19 offset:9216
    ds_read_b64_tr_b16 v[188:189], v20 offset:8192
    ds_read_b64_tr_b16 v[190:191], v20 offset:9216
    v_mfma_f32_32x32x16_bf16 v[32:47], v[116:119], v[112:115], v[32:47]
    v_mfma_f32_32x32x16_bf16 v[48:63], v[120:123], v[112:115], v[48:63]
    v_mfma_f32_32x32x16_bf16 v[64:79], v[124:127], v[112:115], v[64:79]
    s_add_u32 m0, s74, 33792
    s_mov_b32 s76, 640
    buffer_load_dwordx4 v15, s[44:47], s76 offen lds
    s_mov_b64 exec, s[72:73]
    s_add_u32 m0, s75, 67584
    s_mov_b32 s76, 881664
    buffer_load_dwordx4 v16, s[48:51], s76 offen lds
    s_mov_b64 exec, -1
    ds_read_b128 v[192:195], v11 offset:0
    ds_read_b64_tr_b16 v[196:197], v18 offset:12288
    ds_read_b64_tr_b16 v[198:199], v18 offset:13312
    ds_read_b64_tr_b16 v[200:201], v19 offset:12288
    ds_read_b64_tr_b16 v[202:203], v19 offset:13312
    ds_read_b64_tr_b16 v[204:205], v20 offset:12288
    ds_read_b64_tr_b16 v[206:207], v20 offset:13312
    v_mfma_f32_32x32x16_bf16 v[32:47], v[132:135], v[128:131], v[32:47]
    v_mfma_f32_32x32x16_bf16 v[48:63], v[136:139], v[128:131], v[48:63]
    v_mfma_f32_32x32x16_bf16 v[64:79], v[140:143], v[128:131], v[64:79]
    s_mov_b64 exec, s[72:73]
    s_add_u32 m0, s75, 68608
    s_mov_b32 s76, 892416
    buffer_load_dwordx4 v16, s[48:51], s76 offen lds
    s_mov_b64 exec, -1
    s_waitcnt vmcnt(6) lgkmcnt(0)
    s_barrier
    ds_read_b128 v[80:83], v8 offset:16384
    ds_read_b64_tr_b16 v[84:85], v18 offset:32768
    ds_read_b64_tr_b16 v[86:87], v18 offset:33792
    ds_read_b64_tr_b16 v[88:89], v19 offset:32768
    ds_read_b64_tr_b16 v[90:91], v19 offset:33792
    ds_read_b64_tr_b16 v[92:93], v20 offset:32768
    ds_read_b64_tr_b16 v[94:95], v20 offset:33792
    v_mfma_f32_32x32x16_bf16 v[32:47], v[148:151], v[144:147], v[32:47]
    v_mfma_f32_32x32x16_bf16 v[48:63], v[152:155], v[144:147], v[48:63]
    v_mfma_f32_32x32x16_bf16 v[64:79], v[156:159], v[144:147], v[64:79]
    s_add_u32 m0, s74, 0
    s_mov_b32 s76, 768
    buffer_load_dwordx4 v14, s[44:47], s76 offen lds
    s_mov_b64 exec, s[72:73]
    s_add_u32 m0, s75, 0
    s_mov_b32 s76, 1032192
    buffer_load_dwordx4 v16, s[48:51], s76 offen lds
    s_mov_b64 exec, -1
    ds_read_b128 v[96:99], v9 offset:16384
    ds_read_b64_tr_b16 v[100:101], v18 offset:36864
    ds_read_b64_tr_b16 v[102:103], v18 offset:37888
    ds_read_b64_tr_b16 v[104:105], v19 offset:36864
    ds_read_b64_tr_b16 v[106:107], v19 offset:37888
    ds_read_b64_tr_b16 v[108:109], v20 offset:36864
    ds_read_b64_tr_b16 v[110:111], v20 offset:37888
    v_mfma_f32_32x32x16_bf16 v[32:47], v[164:167], v[160:163], v[32:47]
    v_mfma_f32_32x32x16_bf16 v[48:63], v[168:171], v[160:163], v[48:63]
    v_mfma_f32_32x32x16_bf16 v[64:79], v[172:175], v[160:163], v[64:79]
    s_mov_b64 exec, s[72:73]
    s_add_u32 m0, s75, 1024
    s_mov_b32 s76, 1042944
    buffer_load_dwordx4 v16, s[48:51], s76 offen lds
    s_mov_b64 exec, -1
    ds_read_b128 v[112:115], v10 offset:16384
    ds_read_b64_tr_b16 v[116:117], v18 offset:40960
    ds_read_b64_tr_b16 v[118:119], v18 offset:41984
    ds_read_b64_tr_b16 v[120:121], v19 offset:40960
    ds_read_b64_tr_b16 v[122:123], v19 offset:41984
    ds_read_b64_tr_b16 v[124:125], v20 offset:40960
    ds_read_b64_tr_b16 v[126:127], v20 offset:41984
    v_mfma_f32_32x32x16_bf16 v[32:47], v[180:183], v[176:179], v[32:47]
    v_mfma_f32_32x32x16_bf16 v[48:63], v[184:187], v[176:179], v[48:63]
    v_mfma_f32_32x32x16_bf16 v[64:79], v[188:191], v[176:179], v[64:79]
    s_add_u32 m0, s74, 1024
    s_mov_b32 s76, 768
    buffer_load_dwordx4 v15, s[44:47], s76 offen lds
    s_mov_b64 exec, s[72:73]
    s_add_u32 m0, s75, 2048
    s_mov_b32 s76, 1053696
    buffer_load_dwordx4 v16, s[48:51], s76 offen lds
    s_mov_b64 exec, -1
    ds_read_b128 v[128:131], v11 offset:16384
    ds_read_b64_tr_b16 v[132:133], v18 offset:45056
    ds_read_b64_tr_b16 v[134:135], v18 offset:46080
    ds_read_b64_tr_b16 v[136:137], v19 offset:45056
    ds_read_b64_tr_b16 v[138:139], v19 offset:46080
    ds_read_b64_tr_b16 v[140:141], v20 offset:45056
    ds_read_b64_tr_b16 v[142:143], v20 offset:46080
    v_mfma_f32_32x32x16_bf16 v[32:47], v[196:199], v[192:195], v[32:47]
    v_mfma_f32_32x32x16_bf16 v[48:63], v[200:203], v[192:195], v[48:63]
    v_mfma_f32_32x32x16_bf16 v[64:79], v[204:207], v[192:195], v[64:79]
    s_mov_b64 exec, s[72:73]
    s_add_u32 m0, s75, 3072
    s_mov_b32 s76, 1064448
    buffer_load_dwordx4 v16, s[48:51], s76 offen lds
    s_mov_b64 exec, -1
    s_waitcnt vmcnt(6) lgkmcnt(0)
    s_barrier
    ds_read_b128 v[144:147], v8 offset:32768
    ds_read_b64_tr_b16 v[148:149], v21 offset:0
    ds_read_b64_tr_b16 v[150:151], v21 offset:1024
    ds_read_b64_tr_b16 v[152:153], v22 offset:0
    ds_read_b64_tr_b16 v[154:155], v22 offset:1024
    ds_read_b64_tr_b16 v[156:157], v23 offset:0
    ds_read_b64_tr_b16 v[158:159], v23 offset:1024
    v_mfma_f32_32x32x16_bf16 v[32:47], v[84:87], v[80:83], v[32:47]
    v_mfma_f32_32x32x16_bf16 v[48:63], v[88:91], v[80:83], v[48:63]
    v_mfma_f32_32x32x16_bf16 v[64:79], v[92:95], v[80:83], v[64:79]
    ds_read_b128 v[160:163], v9 offset:32768
    ds_read_b64_tr_b16 v[164:165], v21 offset:4096
    ds_read_b64_tr_b16 v[166:167], v21 offset:5120
    ds_read_b64_tr_b16 v[168:169], v22 offset:4096
    ds_read_b64_tr_b16 v[170:171], v22 offset:5120
    ds_read_b64_tr_b16 v[172:173], v23 offset:4096
    ds_read_b64_tr_b16 v[174:175], v23 offset:5120
    v_mfma_f32_32x32x16_bf16 v[32:47], v[100:103], v[96:99], v[32:47]
    v_mfma_f32_32x32x16_bf16 v[48:63], v[104:107], v[96:99], v[48:63]
    v_mfma_f32_32x32x16_bf16 v[64:79], v[108:111], v[96:99], v[64:79]
    ds_read_b128 v[176:179], v10 offset:32768
    ds_read_b64_tr_b16 v[180:181], v21 offset:8192
    ds_read_b64_tr_b16 v[182:183], v21 offset:9216
    ds_read_b64_tr_b16 v[184:185], v22 offset:8192
    ds_read_b64_tr_b16 v[186:187], v22 offset:9216
    ds_read_b64_tr_b16 v[188:189], v23 offset:8192
    ds_read_b64_tr_b16 v[190:191], v23 offset:9216
    v_mfma_f32_32x32x16_bf16 v[32:47], v[116:119], v[112:115], v[32:47]
    v_mfma_f32_32x32x16_bf16 v[48:63], v[120:123], v[112:115], v[48:63]
    v_mfma_f32_32x32x16_bf16 v[64:79], v[124:127], v[112:115], v[64:79]
    ds_read_b128 v[192:195], v11 offset:32768
    ds_read_b64_tr_b16 v[196:197], v21 offset:12288
    ds_read_b64_tr_b16 v[198:199], v21 offset:13312
    ds_read_b64_tr_b16 v[200:201], v22 offset:12288
    ds_read_b64_tr_b16 v[202:203], v22 offset:13312
    ds_read_b64_tr_b16 v[204:205], v23 offset:12288
    ds_read_b64_tr_b16 v[206:207], v23 offset:13312
    v_mfma_f32_32x32x16_bf16 v[32:47], v[132:135], v[128:131], v[32:47]
    v_mfma_f32_32x32x16_bf16 v[48:63], v[136:139], v[128:131], v[48:63]
    v_mfma_f32_32x32x16_bf16 v[64:79], v[140:143], v[128:131], v[64:79]
    s_waitcnt vmcnt(0) lgkmcnt(0)
    s_barrier
    ds_read_b128 v[80:83], v8 offset:0
    ds_read_b64_tr_b16 v[84:85], v18 offset:0
    ds_read_b64_tr_b16 v[86:87], v18 offset:1024
    ds_read_b64_tr_b16 v[88:89], v19 offset:0
    ds_read_b64_tr_b16 v[90:91], v19 offset:1024
    ds_read_b64_tr_b16 v[92:93], v20 offset:0
    ds_read_b64_tr_b16 v[94:95], v20 offset:1024
    v_mfma_f32_32x32x16_bf16 v[32:47], v[148:151], v[144:147], v[32:47]
    v_mfma_f32_32x32x16_bf16 v[48:63], v[152:155], v[144:147], v[48:63]
    v_mfma_f32_32x32x16_bf16 v[64:79], v[156:159], v[144:147], v[64:79]
    ds_read_b128 v[96:99], v9 offset:0
    ds_read_b64_tr_b16 v[100:101], v18 offset:4096
    ds_read_b64_tr_b16 v[102:103], v18 offset:5120
    ds_read_b64_tr_b16 v[104:105], v19 offset:4096
    ds_read_b64_tr_b16 v[106:107], v19 offset:5120
    ds_read_b64_tr_b16 v[108:109], v20 offset:4096
    ds_read_b64_tr_b16 v[110:111], v20 offset:5120
    v_mfma_f32_32x32x16_bf16 v[32:47], v[164:167], v[160:163], v[32:47]
    v_mfma_f32_32x32x16_bf16 v[48:63], v[168:171], v[160:163], v[48:63]
    v_mfma_f32_32x32x16_bf16 v[64:79], v[172:175], v[160:163], v[64:79]
    ds_read_b128 v[112:115], v10 offset:0
    ds_read_b64_tr_b16 v[116:117], v18 offset:8192
    ds_read_b64_tr_b16 v[118:119], v18 offset:9216
    ds_read_b64_tr_b16 v[120:121], v19 offset:8192
    ds_read_b64_tr_b16 v[122:123], v19 offset:9216
    ds_read_b64_tr_b16 v[124:125], v20 offset:8192
    ds_read_b64_tr_b16 v[126:127], v20 offset:9216
    v_mfma_f32_32x32x16_bf16 v[32:47], v[180:183], v[176:179], v[32:47]
    v_mfma_f32_32x32x16_bf16 v[48:63], v[184:187], v[176:179], v[48:63]
    v_mfma_f32_32x32x16_bf16 v[64:79], v[188:191], v[176:179], v[64:79]
    ds_read_b128 v[128:131], v11 offset:0
    ds_read_b64_tr_b16 v[132:133], v18 offset:12288
    ds_read_b64_tr_b16 v[134:135], v18 offset:13312
    ds_read_b64_tr_b16 v[136:137], v19 offset:12288
    ds_read_b64_tr_b16 v[138:139], v19 offset:13312
    ds_read_b64_tr_b16 v[140:141], v20 offset:12288
    ds_read_b64_tr_b16 v[142:143], v20 offset:13312
    v_mfma_f32_32x32x16_bf16 v[32:47], v[196:199], v[192:195], v[32:47]
    v_mfma_f32_32x32x16_bf16 v[48:63], v[200:203], v[192:195], v[48:63]
    v_mfma_f32_32x32x16_bf16 v[64:79], v[204:207], v[192:195], v[64:79]
    s_waitcnt lgkmcnt(0)
    v_mfma_f32_32x32x16_bf16 v[32:47], v[84:87], v[80:83], v[32:47]
    v_mfma_f32_32x32x16_bf16 v[48:63], v[88:91], v[80:83], v[48:63]
    v_mfma_f32_32x32x16_bf16 v[64:79], v[92:95], v[80:83], v[64:79]
    v_mfma_f32_32x32x16_bf16 v[32:47], v[100:103], v[96:99], v[32:47]
    v_mfma_f32_32x32x16_bf16 v[48:63], v[104:107], v[96:99], v[48:63]
    v_mfma_f32_32x32x16_bf16 v[64:79], v[108:111], v[96:99], v[64:79]
    v_mfma_f32_32x32x16_bf16 v[32:47], v[116:119], v[112:115], v[32:47]
    v_mfma_f32_32x32x16_bf16 v[48:63], v[120:123], v[112:115], v[48:63]
    v_mfma_f32_32x32x16_bf16 v[64:79], v[124:127], v[112:115], v[64:79]
    v_mfma_f32_32x32x16_bf16 v[32:47], v[132:135], v[128:131], v[32:47]
    v_mfma_f32_32x32x16_bf16 v[48:63], v[136:139], v[128:131], v[48:63]
    v_mfma_f32_32x32x16_bf16 v[64:79], v[140:143], v[128:131], v[64:79]
    s_branch k1_epi
k1_nnv:
    s_add_u32 m0, s74, 0
    s_mov_b32 s76, 0
    buffer_load_dwordx4 v14, s[44:47], s76 offen lds
    s_mov_b64 exec, s[72:73]
    s_add_u32 m0, s75, 0
    s_mov_b32 s76, 0
    buffer_load_dwordx4 v16, s[48:51], s76 offen lds
    s_mov_b64 exec, -1
    s_mov_b64 exec, s[72:73]
    s_add_u32 m0, s75, 1024
    s_mov_b32 s76, 10752
    buffer_load_dwordx4 v16, s[48:51], s76 offen lds
    s_mov_b64 exec, -1
    s_add_u32 m0, s74, 1024
    s_mov_b32 s76, 0
    buffer_load_dwordx4 v15, s[44:47], s76 offen lds
    s_mov_b64 exec, s[72:73]
    s_add_u32 m0, s75, 2048
    s_mov_b32 s76, 21504
    buffer_load_dwordx4 v16, s[48:51], s76 offen lds
    s_mov_b64 exec, -1
    s_mov_b64 exec, s[72:73]
    s_add_u32 m0, s75, 3072
    s_mov_b32 s76, 32256
    buffer_load_dwordx4 v16, s[48:51], s76 offen lds
    s_mov_b64 exec, -1
    s_add_u32 m0, s74, 16384
    s_mov_b32 s76, 128
    buffer_load_dwordx4 v14, s[44:47], s76 offen lds
    s_mov_b64 exec, s[72:73]
    s_add_u32 m0, s75, 32768
    s_mov_b32 s76, 172032
    buffer_load_dwordx4 v16, s[48:51], s76 offen lds
    s_mov_b64 exec, -1
    s_mov_b64 exec, s[72:73]
    s_add_u32 m0, s75, 33792
    s_mov_b32 s76, 182784
    buffer_load_dwordx4 v16, s[48:51], s76 offen lds
    s_mov_b64 exec, -1
    s_add_u32 m0, s74, 17408
    s_mov_b32 s76, 128
    buffer_load_dwordx4 v15, s[44:47], s76 offen lds
    s_mov_b64 exec, s[72:73]
    s_add_u32 m0, s75, 34816
    s_mov_b32 s76, 193536
    buffer_load_dwordx4 v16, s[48:51], s76 offen lds
    s_mov_b64 exec, -1
    s_mov_b64 exec, s[72:73]
    s_add_u32 m0, s75, 35840
    s_mov_b32 s76, 204288
    buffer_load_dwordx4 v16, s[48:51], s76 offen lds
    s_mov_b64 exec, -1
    s_lshl_b32 s80, s7, 4
    s_add_u32 s80, s80, s6
    s_cmp_ge_u32 s3, 4
    s_cbranch_scc1 pfh2
    s_mul_i32 s81, s80, 112
    s_mov_b32 s82, s3
    s_mul_i32 s82, s82, 28
    s_add_u32 s81, s81, s82
    v_add_u32 v224, s81, v0
    v_lshlrev_b32 v224, 7, v224
    v_cmp_gt_u32 vcc, 28, v0
    v_mov_b32 v225, 0x7fffff00
    s_nop 0
    v_cndmask_b32 v224, v225, v224, vcc
    buffer_load_dword v224, v224, s[44:47], 0 offen
    s_branch pfe2
pfh2:
    s_mul_i32 s81, s80, 74
    s_sub_u32 s82, s3, 4
    s_mul_i32 s82, s82, 19
    s_add_u32 s81, s81, s82
    v_add_u32 v224, s81, v0
    v_lshlrev_b32 v224, 7, v224
    v_cmp_gt_u32 vcc, 19, v0
    v_mov_b32 v225, 0x7fffff00
    s_nop 0
    v_cndmask_b32 v224, v225, v224, vcc
    buffer_load_dword v224, v224, s[48:51], 0 offen
pfe2:
    s_waitcnt vmcnt(7) lgkmcnt(0)
    s_barrier
    ds_read_b128 v[80:83], v8 offset:0
    ds_read_b64_tr_b16 v[84:85], v18 offset:0
    ds_read_b64_tr_b16 v[86:87], v18 offset:1024
    ds_read_b64_tr_b16 v[88:89], v19 offset:0
    ds_read_b64_tr_b16 v[90:91], v19 offset:1024
    ds_read_b64_tr_b16 v[92:93], v20 offset:0
    ds_read_b64_tr_b16 v[94:95], v20 offset:1024
    s_add_u32 m0, s74, 32768
    s_mov_b32 s76, 256
    buffer_load_dwordx4 v14, s[44:47], s76 offen lds
    s_mov_b64 exec, s[72:73]
    s_add_u32 m0, s75, 65536
    s_mov_b32 s76, 344064
    buffer_load_dwordx4 v16, s[48:51], s76 offen lds
    s_mov_b64 exec, -1
    ds_read_b128 v[96:99], v9 offset:0
    ds_read_b64_tr_b16 v[100:101], v18 offset:4096
    ds_read_b64_tr_b16 v[102:103], v18 offset:5120
    ds_read_b64_tr_b16 v[104:105], v19 offset:4096
    ds_read_b64_tr_b16 v[106:107], v19 offset:5120
    ds_read_b64_tr_b16 v[108:109], v20 offset:4096
    ds_read_b64_tr_b16 v[110:111], v20 offset:5120
    s_mov_b64 exec, s[72:73]
    s_add_u32 m0, s75, 66560
    s_mov_b32 s76, 354816
    buffer_load_dwordx4 v16, s[48:51], s76 offen lds
    s_mov_b64 exec, -1
    ds_read_b128 v[112:115], v10 offset:0
    ds_read_b64_tr_b16 v[116:117], v18 offset:8192
    ds_read_b64_tr_b16 v[118:119], v18 offset:9216
    ds_read_b64_tr_b16 v[120:121], v19 offset:8192
    ds_read_b64_tr_b16 v[122:123], v19 offset:9216
    ds_read_b64_tr_b16 v[124:125], v20 offset:8192
    ds_read_b64_tr_b16 v[126:127], v20 offset:9216
    s_add_u32 m0, s74, 33792
    s_mov_b32 s76, 256
    buffer_load_dwordx4 v15, s[44:47], s76 offen lds
    s_mov_b64 exec, s[72:73]
    s_add_u32 m0, s75, 67584
    s_mov_b32 s76, 365568
    buffer_load_dwordx4 v16, s[48:51], s76 offen lds
    s_mov_b64 exec, -1
    ds_read_b128 v[128:131], v11 offset:0
    ds_read_b64_tr_b16 v[132:133], v18 offset:12288
    ds_read_b64_tr_b16 v[134:135], v18 offset:13312
    ds_read_b64_tr_b16 v[136:137], v19 offset:12288
    ds_read_b64_tr_b16 v[138:139], v19 offset:13312
    ds_read_b64_tr_b16 v[140:141], v20 offset:12288
    ds_read_b64_tr_b16 v[142:143], v20 offset:13312
    s_mov_b64 exec, s[72:73]
    s_add_u32 m0, s75, 68608
    s_mov_b32 s76, 376320
    buffer_load_dwordx4 v16, s[48:51], s76 offen lds
    s_mov_b64 exec, -1
    s_waitcnt vmcnt(7) lgkmcnt(0)
    s_barrier
    ds_read_b128 v[144:147], v8 offset:16384
    ds_read_b64_tr_b16 v[148:149], v18 offset:32768
    ds_read_b64_tr_b16 v[150:151], v18 offset:33792
    ds_read_b64_tr_b16 v[152:153], v19 offset:32768
    ds_read_b64_tr_b16 v[154:155], v19 offset:33792
    ds_read_b64_tr_b16 v[156:157], v20 offset:32768
    ds_read_b64_tr_b16 v[158:159], v20 offset:33792
    v_mfma_f32_32x32x16_bf16 v[32:47], v[84:87], v[80:83], 0
    v_mfma_f32_32x32x16_bf16 v[48:63], v[88:91], v[80:83], 0
    v_mfma_f32_32x32x16_bf16 v[64:79], v[80:83], v[92:95], 0
    s_add_u32 m0, s74, 0
    s_mov_b32 s76, 384
    buffer_load_dwordx4 v14, s[44:47], s76 offen lds
    s_mov_b64 exec, s[72:73]
    s_add_u32 m0, s75, 0
    s_mov_b32 s76, 516096
    buffer_load_dwordx4 v16, s[48:51], s76 offen lds
    s_mov_b64 exec, -1
    ds_read_b128 v[160:163], v9 offset:16384
    ds_read_b64_tr_b16 v[164:165], v18 offset:36864
    ds_read_b64_tr_b16 v[166:167], v18 offset:37888
    ds_read_b64_tr_b16 v[168:169], v19 offset:36864
    ds_read_b64_tr_b16 v[170:171], v19 offset:37888
    ds_read_b64_tr_b16 v[172:173], v20 offset:36864
    ds_read_b64_tr_b16 v[174:175], v20 offset:37888
    v_mfma_f32_32x32x16_bf16 v[32:47], v[100:103], v[96:99], v[32:47]
    v_mfma_f32_32x32x16_bf16 v[48:63], v[104:107], v[96:99], v[48:63]
    v_mfma_f32_32x32x16_bf16 v[64:79], v[96:99], v[108:111], v[64:79]
    s_mov_b64 exec, s[72:73]
    s_add_u32 m0, s75, 1024
    s_mov_b32 s76, 526848
    buffer_load_dwordx4 v16, s[48:51], s76 offen lds
    s_mov_b64 exec, -1
    ds_read_b128 v[176:179], v10 offset:16384
    ds_read_b64_tr_b16 v[180:181], v18 offset:40960
    ds_read_b64_tr_b16 v[182:183], v18 offset:41984
    ds_read_b64_tr_b16 v[184:185], v19 offset:40960
    ds_read_b64_tr_b16 v[186:187], v19 offset:41984
    ds_read_b64_tr_b16 v[188:189], v20 offset:40960
    ds_read_b64_tr_b16 v[190:191], v20 offset:41984
    v_mfma_f32_32x32x16_bf16 v[32:47], v[116:119], v[112:115], v[32:47]
    v_mfma_f32_32x32x16_bf16 v[48:63], v[120:123], v[112:115], v[48:63]
    v_mfma_f32_32x32x16_bf16 v[64:79], v[112:115], v[124:127], v[64:79]
    s_add_u32 m0, s74, 1024
    s_mov_b32 s76, 384
    buffer_load_dwordx4 v15, s[44:47], s76 offen lds
    s_mov_b64 exec, s[72:73]
    s_add_u32 m0, s75, 2048
    s_mov_b32 s76, 537600
    buffer_load_dwordx4 v16, s[48:51], s76 offen lds
    s_mov_b64 exec, -1
    ds_read_b128 v[192:195], v11 offset:16384
    ds_read_b64_tr_b16 v[196:197], v18 offset:45056
    ds_read_b64_tr_b16 v[198:199], v18 offset:46080
    ds_read_b64_tr_b16 v[200:201], v19 offset:45056
    ds_read_b64_tr_b16 v[202:203], v19 offset:46080
    ds_read_b64_tr_b16 v[204:205], v20 offset:45056
    ds_read_b64_tr_b16 v[206:207], v20 offset:46080
    v_mfma_f32_32x32x16_bf16 v[32:47], v[132:135], v[128:131], v[32:47]
    v_mfma_f32_32x32x16_bf16 v[48:63], v[136:139], v[128:131], v[48:63]
    v_mfma_f32_32x32x16_bf16 v[64:79], v[128:131], v[140:143], v[64:79]
    s_mov_b64 exec, s[72:73]
    s_add_u32 m0, s75, 3072
    s_mov_b32 s76, 548352
    buffer_load_dwordx4 v16, s[48:51], s76 offen lds
    s_mov_b64 exec, -1
    s_waitcnt vmcnt(6) lgkmcnt(0)
    s_barrier
    ds_read_b128 v[80:83], v8 offset:32768
    ds_read_b64_tr_b16 v[84:85], v21 offset:0
    ds_read_b64_tr_b16 v[86:87], v21 offset:1024
    ds_read_b64_tr_b16 v[88:89], v22 offset:0
    ds_read_b64_tr_b16 v[90:91], v22 offset:1024
    ds_read_b64_tr_b16 v[92:93], v23 offset:0
    ds_read_b64_tr_b16 v[94:95], v23 offset:1024
    v_mfma_f32_32x32x16_bf16 v[32:47], v[148:151], v[144:147], v[32:47]
    v_mfma_f32_32x32x16_bf16 v[48:63], v[152:155], v[144:147], v[48:63]
    v_mfma_f32_32x32x16_bf16 v[64:79], v[144:147], v[156:159], v[64:79]
    s_add_u32 m0, s74, 16384
    s_mov_b32 s76, 512
    buffer_load_dwordx4 v14, s[44:47], s76 offen lds
    s_mov_b64 exec, s[72:73]
    s_add_u32 m0, s75, 32768
    s_mov_b32 s76, 688128
    buffer_load_dwordx4 v16, s[48:51], s76 offen lds
    s_mov_b64 exec, -1
    ds_read_b128 v[96:99], v9 offset:32768
    ds_read_b64_tr_b16 v[100:101], v21 offset:4096
    ds_read_b64_tr_b16 v[102:103], v21 offset:5120
    ds_read_b64_tr_b16 v[104:105], v22 offset:4096
    ds_read_b64_tr_b16 v[106:107], v22 offset:5120
    ds_read_b64_tr_b16 v[108:109], v23 offset:4096
    ds_read_b64_tr_b16 v[110:111], v23 offset:5120
    v_mfma_f32_32x32x16_bf16 v[32:47], v[164:167], v[160:163], v[32:47]
    v_mfma_f32_32x32x16_bf16 v[48:63], v[168:171], v[160:163], v[48:63]
    v_mfma_f32_32x32x16_bf16 v[64:79], v[160:163], v[172:175], v[64:79]
    s_mov_b64 exec, s[72:73]
    s_add_u32 m0, s75, 33792
    s_mov_b32 s76, 698880
    buffer_load_dwordx4 v16, s[48:51], s76 offen lds
    s_mov_b64 exec, -1
    ds_read_b128 v[112:115], v10 offset:32768
    ds_read_b64_tr_b16 v[116:117], v21 offset:8192
    ds_read_b64_tr_b16 v[118:119], v21 offset:9216
    ds_read_b64_tr_b16 v[120:121], v22 offset:8192
    ds_read_b64_tr_b16 v[122:123], v22 offset:9216
    ds_read_b64_tr_b16 v[124:125], v23 offset:8192
    ds_read_b64_tr_b16 v[126:127], v23 offset:9216
    v_mfma_f32_32x32x16_bf16 v[32:47], v[180:183], v[176:179], v[32:47]
    v_mfma_f32_32x32x16_bf16 v[48:63], v[184:187], v[176:179], v[48:63]
    v_mfma_f32_32x32x16_bf16 v[64:79], v[176:179], v[188:191], v[64:79]
    s_add_u32 m0, s74, 17408
    s_mov_b32 s76, 512
    buffer_load_dwordx4 v15, s[44:47], s76 offen lds
    s_mov_b64 exec, s[72:73]
    s_add_u32 m0, s75, 34816
    s_mov_b32 s76, 709632
    buffer_load_dwordx4 v16, s[48:51], s76 offen lds
    s_mov_b64 exec, -1
    ds_read_b128 v[128:131], v11 offset:32768
    ds_read_b64_tr_b16 v[132:133], v21 offset:12288
    ds_read_b64_tr_b16 v[134:135], v21 offset:13312
    ds_read_b64_tr_b16 v[136:137], v22 offset:12288
    ds_read_b64_tr_b16 v[138:139], v22 offset:13312
    ds_read_b64_tr_b16 v[140:141], v23 offset:12288
    ds_read_b64_tr_b16 v[142:143], v23 offset:13312
    v_mfma_f32_32x32x16_bf16 v[32:47], v[196:199], v[192:195], v[32:47]
    v_mfma_f32_32x32x16_bf16 v[48:63], v[200:203], v[192:195], v[48:63]
    v_mfma_f32_32x32x16_bf16 v[64:79], v[192:195], v[204:207], v[64:79]
    s_mov_b64 exec, s[72:73]
    s_add_u32 m0, s75, 35840
    s_mov_b32 s76, 720384
    buffer_load_dwordx4 v16, s[48:51], s76 offen lds
    s_mov_b64 exec, -1
    s_waitcnt vmcnt(6) lgkmcnt(0)
    s_barrier
    ds_read_b128 v[144:147], v8 offset:0
    ds_read_b64_tr_b16 v[148:149], v18 offset:0
    ds_read_b64_tr_b16 v[150:151], v18 offset:1024
    ds_read_b64_tr_b16 v[152:153], v19 offset:0
    ds_read_b64_tr_b16 v[154:155], v19 offset:1024
    ds_read_b64_tr_b16 v[156:157], v20 offset:0
    ds_read_b64_tr_b16 v[158:159], v20 offset:1024
    v_mfma_f32_32x32x16_bf16 v[32:47], v[84:87], v[80:83], v[32:47]
    v_mfma_f32_32x32x16_bf16 v[48:63], v[88:91], v[80:83], v[48:63]
    v_mfma_f32_32x32x16_bf16 v[64:79], v[80:83], v[92:95], v[64:79]
    s_add_u32 m0, s74, 32768
    s_mov_b32 s76, 640
    buffer_load_dwordx4 v14, s[44:47], s76 offen lds
    s_mov_b64 exec, s[72:73]
    s_add_u32 m0, s75, 65536
    s_mov_b32 s76, 860160
    buffer_load_dwordx4 v16, s[48:51], s76 offen lds
    s_mov_b64 exec, -1
    ds_read_b128 v[160:163], v9 offset:0
    ds_read_b64_tr_b16 v[164:165], v18 offset:4096
    ds_read_b64_tr_b16 v[166:167], v18 offset:5120
    ds_read_b64_tr_b16 v[168:169], v19 offset:4096
    ds_read_b64_tr_b16 v[170:171], v19 offset:5120
    ds_read_b64_tr_b16 v[172:173], v20 offset:4096
    ds_read_b64_tr_b16 v[174:175], v20 offset:5120
    v_mfma_f32_32x32x16_bf16 v[32:47], v[100:103], v[96:99], v[32:47]
    v_mfma_f32_32x32x16_bf16 v[48:63], v[104:107], v[96:99], v[48:63]
    v_mfma_f32_32x32x16_bf16 v[64:79], v[96:99], v[108:111], v[64:79]
    s_mov_b64 exec, s[72:73]
    s_add_u32 m0, s75, 66560
    s_mov_b32 s76, 870912
    buffer_load_dwordx4 v16, s[48:51], s76 offen lds
    s_mov_b64 exec, -1
    ds_read_b128 v[176:179], v10 offset:0
    ds_read_b64_tr_b16 v[180:181], v18 offset:8192
    ds_read_b64_tr_b16 v[182:183], v18 offset:9216
    ds_read_b64_tr_b16 v[184:185], v19 offset:8192
    ds_read_b64_tr_b16 v[186:187], v19 offset:9216
    ds_read_b64_tr_b16 v[188:189], v20 offset:8192
    ds_read_b64_tr_b16 v[190:191], v20 offset:9216
    v_mfma_f32_32x32x16_bf16 v[32:47], v[116:119], v[112:115], v[32:47]
    v_mfma_f32_32x32x16_bf16 v[48:63], v[120:123], v[112:115], v[48:63]
    v_mfma_f32_32x32x16_bf16 v[64:79], v[112:115], v[124:127], v[64:79]
    s_add_u32 m0, s74, 33792
    s_mov_b32 s76, 640
    buffer_load_dwordx4 v15, s[44:47], s76 offen lds
    s_mov_b64 exec, s[72:73]
    s_add_u32 m0, s75, 67584
    s_mov_b32 s76, 881664
    buffer_load_dwordx4 v16, s[48:51], s76 offen lds
    s_mov_b64 exec, -1
    ds_read_b128 v[192:195], v11 offset:0
    ds_read_b64_tr_b16 v[196:197], v18 offset:12288
    ds_read_b64_tr_b16 v[198:199], v18 offset:13312
    ds_read_b64_tr_b16 v[200:201], v19 offset:12288
    ds_read_b64_tr_b16 v[202:203], v19 offset:13312
    ds_read_b64_tr_b16 v[204:205], v20 offset:12288
    ds_read_b64_tr_b16 v[206:207], v20 offset:13312
    v_mfma_f32_32x32x16_bf16 v[32:47], v[132:135], v[128:131], v[32:47]
    v_mfma_f32_32x32x16_bf16 v[48:63], v[136:139], v[128:131], v[48:63]
    v_mfma_f32_32x32x16_bf16 v[64:79], v[128:131], v[140:143], v[64:79]
    s_mov_b64 exec, s[72:73]
    s_add_u32 m0, s75, 68608
    s_mov_b32 s76, 892416
    buffer_load_dwordx4 v16, s[48:51], s76 offen lds
    s_mov_b64 exec, -1
    s_waitcnt vmcnt(6) lgkmcnt(0)
    s_barrier
    ds_read_b128 v[80:83], v8 offset:16384
    ds_read_b64_tr_b16 v[84:85], v18 offset:32768
    ds_read_b64_tr_b16 v[86:87], v18 offset:33792
    ds_read_b64_tr_b16 v[88:89], v19 offset:32768
    ds_read_b64_tr_b16 v[90:91], v19 offset:33792
    ds_read_b64_tr_b16 v[92:93], v20 offset:32768
    ds_read_b64_tr_b16 v[94:95], v20 offset:33792
    v_mfma_f32_32x32x16_bf16 v[32:47], v[148:151], v[144:147], v[32:47]
    v_mfma_f32_32x32x16_bf16 v[48:63], v[152:155], v[144:147], v[48:63]
    v_mfma_f32_32x32x16_bf16 v[64:79], v[144:147], v[156:159], v[64:79]
    s_add_u32 m0, s74, 0
    s_mov_b32 s76, 768
    buffer_load_dwordx4 v14, s[44:47], s76 offen lds
    s_mov_b64 exec, s[72:73]
    s_add_u32 m0, s75, 0
    s_mov_b32 s76, 1032192
    buffer_load_dwordx4 v16, s[48:51], s76 offen lds
    s_mov_b64 exec, -1
    ds_read_b128 v[96:99], v9 offset:16384
    ds_read_b64_tr_b16 v[100:101], v18 offset:36864
    ds_read_b64_tr_b16 v[102:103], v18 offset:37888
    ds_read_b64_tr_b16 v[104:105], v19 offset:36864
    ds_read_b64_tr_b16 v[106:107], v19 offset:37888
    ds_read_b64_tr_b16 v[108:109], v20 offset:36864
    ds_read_b64_tr_b16 v[110:111], v20 offset:37888
    v_mfma_f32_32x32x16_bf16 v[32:47], v[164:167], v[160:163], v[32:47]
    v_mfma_f32_32x32x16_bf16 v[48:63], v[168:171], v[160:163], v[48:63]
    v_mfma_f32_32x32x16_bf16 v[64:79], v[160:163], v[172:175], v[64:79]
    s_mov_b64 exec, s[72:73]
    s_add_u32 m0, s75, 1024
    s_mov_b32 s76, 1042944
    buffer_load_dwordx4 v16, s[48:51], s76 offen lds
    s_mov_b64 exec, -1
    ds_read_b128 v[112:115], v10 offset:16384
    ds_read_b64_tr_b16 v[116:117], v18 offset:40960
    ds_read_b64_tr_b16 v[118:119], v18 offset:41984
    ds_read_b64_tr_b16 v[120:121], v19 offset:40960
    ds_read_b64_tr_b16 v[122:123], v19 offset:41984
    ds_read_b64_tr_b16 v[124:125], v20 offset:40960
    ds_read_b64_tr_b16 v[126:127], v20 offset:41984
    v_mfma_f32_32x32x16_bf16 v[32:47], v[180:183], v[176:179], v[32:47]
    v_mfma_f32_32x32x16_bf16 v[48:63], v[184:187], v[176:179], v[48:63]
    v_mfma_f32_32x32x16_bf16 v[64:79], v[176:179], v[188:191], v[64:79]
    s_add_u32 m0, s74, 1024
    s_mov_b32 s76, 768
    buffer_load_dwordx4 v15, s[44:47], s76 offen lds
    s_mov_b64 exec, s[72:73]
    s_add_u32 m0, s75, 2048
    s_mov_b32 s76, 1053696
    buffer_load_dwordx4 v16, s[48:51], s76 offen lds
    s_mov_b64 exec, -1
    ds_read_b128 v[128:131], v11 offset:16384
    ds_read_b64_tr_b16 v[132:133], v18 offset:45056
    ds_read_b64_tr_b16 v[134:135], v18 offset:46080
    ds_read_b64_tr_b16 v[136:137], v19 offset:45056
    ds_read_b64_tr_b16 v[138:139], v19 offset:46080
    ds_read_b64_tr_b16 v[140:141], v20 offset:45056
    ds_read_b64_tr_b16 v[142:143], v20 offset:46080
    v_mfma_f32_32x32x16_bf16 v[32:47], v[196:199], v[192:195], v[32:47]
    v_mfma_f32_32x32x16_bf16 v[48:63], v[200:203], v[192:195], v[48:63]
    v_mfma_f32_32x32x16_bf16 v[64:79], v[192:195], v[204:207], v[64:79]
    s_mov_b64 exec, s[72:73]
    s_add_u32 m0, s75, 3072
    s_mov_b32 s76, 1064448
    buffer_load_dwordx4 v16, s[48:51], s76 offen lds
    s_mov_b64 exec, -1
    s_waitcnt vmcnt(6) lgkmcnt(0)
    s_barrier
    ds_read_b128 v[144:147], v8 offset:32768
    ds_read_b64_tr_b16 v[148:149], v21 offset:0
    ds_read_b64_tr_b16 v[150:151], v21 offset:1024
    ds_read_b64_tr_b16 v[152:153], v22 offset:0
    ds_read_b64_tr_b16 v[154:155], v22 offset:1024
    ds_read_b64_tr_b16 v[156:157], v23 offset:0
    ds_read_b64_tr_b16 v[158:159], v23 offset:1024
    v_mfma_f32_32x32x16_bf16 v[32:47], v[84:87], v[80:83], v[32:47]
    v_mfma_f32_32x32x16_bf16 v[48:63], v[88:91], v[80:83], v[48:63]
    v_mfma_f32_32x32x16_bf16 v[64:79], v[80:83], v[92:95], v[64:79]
    ds_read_b128 v[160:163], v9 offset:32768
    ds_read_b64_tr_b16 v[164:165], v21 offset:4096
    ds_read_b64_tr_b16 v[166:167], v21 offset:5120
    ds_read_b64_tr_b16 v[168:169], v22 offset:4096
    ds_read_b64_tr_b16 v[170:171], v22 offset:5120
    ds_read_b64_tr_b16 v[172:173], v23 offset:4096
    ds_read_b64_tr_b16 v[174:175], v23 offset:5120
    v_mfma_f32_32x32x16_bf16 v[32:47], v[100:103], v[96:99], v[32:47]
    v_mfma_f32_32x32x16_bf16 v[48:63], v[104:107], v[96:99], v[48:63]
    v_mfma_f32_32x32x16_bf16 v[64:79], v[96:99], v[108:111], v[64:79]
    ds_read_b128 v[176:179], v10 offset:32768
    ds_read_b64_tr_b16 v[180:181], v21 offset:8192
    ds_read_b64_tr_b16 v[182:183], v21 offset:9216
    ds_read_b64_tr_b16 v[184:185], v22 offset:8192
    ds_read_b64_tr_b16 v[186:187], v22 offset:9216
    ds_read_b64_tr_b16 v[188:189], v23 offset:8192
    ds_read_b64_tr_b16 v[190:191], v23 offset:9216
    v_mfma_f32_32x32x16_bf16 v[32:47], v[116:119], v[112:115], v[32:47]
    v_mfma_f32_32x32x16_bf16 v[48:63], v[120:123], v[112:115], v[48:63]
    v_mfma_f32_32x32x16_bf16 v[64:79], v[112:115], v[124:127], v[64:79]
    ds_read_b128 v[192:195], v11 offset:32768
    ds_read_b64_tr_b16 v[196:197], v21 offset:12288
    ds_read_b64_tr_b16 v[198:199], v21 offset:13312
    ds_read_b64_tr_b16 v[200:201], v22 offset:12288
    ds_read_b64_tr_b16 v[202:203], v22 offset:13312
    ds_read_b64_tr_b16 v[204:205], v23 offset:12288
    ds_read_b64_tr_b16 v[206:207], v23 offset:13312
    v_mfma_f32_32x32x16_bf16 v[32:47], v[132:135], v[128:131], v[32:47]
    v_mfma_f32_32x32x16_bf16 v[48:63], v[136:139], v[128:131], v[48:63]
    v_mfma_f32_32x32x16_bf16 v[64:79], v[128:131], v[140:143], v[64:79]
    s_waitcnt vmcnt(0) lgkmcnt(0)
    s_barrier
    ds_read_b128 v[80:83], v8 offset:0
    ds_read_b64_tr_b16 v[84:85], v18 offset:0
    ds_read_b64_tr_b16 v[86:87], v18 offset:1024
    ds_read_b64_tr_b16 v[88:89], v19 offset:0
    ds_read_b64_tr_b16 v[90:91], v19 offset:1024
    ds_read_b64_tr_b16 v[92:93], v20 offset:0
    ds_read_b64_tr_b16 v[94:95], v20 offset:1024
    v_mfma_f32_32x32x16_bf16 v[32:47], v[148:151], v[144:147], v[32:47]
    v_mfma_f32_32x32x16_bf16 v[48:63], v[152:155], v[144:147], v[48:63]
    v_mfma_f32_32x32x16_bf16 v[64:79], v[144:147], v[156:159], v[64:79]
    ds_read_b128 v[96:99], v9 offset:0
    ds_read_b64_tr_b16 v[100:101], v18 offset:4096
    ds_read_b64_tr_b16 v[102:103], v18 offset:5120
    ds_read_b64_tr_b16 v[104:105], v19 offset:4096
    ds_read_b64_tr_b16 v[106:107], v19 offset:5120
    ds_read_b64_tr_b16 v[108:109], v20 offset:4096
    ds_read_b64_tr_b16 v[110:111], v20 offset:5120
    v_mfma_f32_32x32x16_bf16 v[32:47], v[164:167], v[160:163], v[32:47]
    v_mfma_f32_32x32x16_bf16 v[48:63], v[168:171], v[160:163], v[48:63]
    v_mfma_f32_32x32x16_bf16 v[64:79], v[160:163], v[172:175], v[64:79]
    ds_read_b128 v[112:115], v10 offset:0
    ds_read_b64_tr_b16 v[116:117], v18 offset:8192
    ds_read_b64_tr_b16 v[118:119], v18 offset:9216
    ds_read_b64_tr_b16 v[120:121], v19 offset:8192
    ds_read_b64_tr_b16 v[122:123], v19 offset:9216
    ds_read_b64_tr_b16 v[124:125], v20 offset:8192
    ds_read_b64_tr_b16 v[126:127], v20 offset:9216
    v_mfma_f32_32x32x16_bf16 v[32:47], v[180:183], v[176:179], v[32:47]
    v_mfma_f32_32x32x16_bf16 v[48:63], v[184:187], v[176:179], v[48:63]
    v_mfma_f32_32x32x16_bf16 v[64:79], v[176:179], v[188:191], v[64:79]
    ds_read_b128 v[128:131], v11 offset:0
    ds_read_b64_tr_b16 v[132:133], v18 offset:12288
    ds_read_b64_tr_b16 v[134:135], v18 offset:13312
    ds_read_b64_tr_b16 v[136:137], v19 offset:12288
    ds_read_b64_tr_b16 v[138:139], v19 offset:13312
    ds_read_b64_tr_b16 v[140:141], v20 offset:12288
    ds_read_b64_tr_b16 v[142:143], v20 offset:13312
    v_mfma_f32_32x32x16_bf16 v[32:47], v[196:199], v[192:195], v[32:47]
    v_mfma_f32_32x32x16_bf16 v[48:63], v[200:203], v[192:195], v[48:63]
    v_mfma_f32_32x32x16_bf16 v[64:79], v[192:195], v[204:207], v[64:79]
    s_waitcnt lgkmcnt(0)
    v_mfma_f32_32x32x16_bf16 v[32:47], v[84:87], v[80:83], v[32:47]
    v_mfma_f32_32x32x16_bf16 v[48:63], v[88:91], v[80:83], v[48:63]
    v_mfma_f32_32x32x16_bf16 v[64:79], v[80:83], v[92:95], v[64:79]
    v_mfma_f32_32x32x16_bf16 v[32:47], v[100:103], v[96:99], v[32:47]
    v_mfma_f32_32x32x16_bf16 v[48:63], v[104:107], v[96:99], v[48:63]
    v_mfma_f32_32x32x16_bf16 v[64:79], v[96:99], v[108:111], v[64:79]
    v_mfma_f32_32x32x16_bf16 v[32:47], v[116:119], v[112:115], v[32:47]
    v_mfma_f32_32x32x16_bf16 v[48:63], v[120:123], v[112:115], v[48:63]
    v_mfma_f32_32x32x16_bf16 v[64:79], v[112:115], v[124:127], v[64:79]
    v_mfma_f32_32x32x16_bf16 v[32:47], v[132:135], v[128:131], v[32:47]
    v_mfma_f32_32x32x16_bf16 v[48:63], v[136:139], v[128:131], v[48:63]
    v_mfma_f32_32x32x16_bf16 v[64:79], v[128:131], v[140:143], v[64:79]
    s_branch k1_epi
k1_vvv:
    s_add_u32 m0, s74, 0
    s_mov_b32 s76, 0
    buffer_load_dwordx4 v14, s[44:47], s76 offen lds
    s_mov_b64 exec, s[72:73]
    s_add_u32 m0, s75, 0
    s_mov_b32 s76, 0
    buffer_load_dwordx4 v16, s[48:51], s76 offen lds
    s_mov_b64 exec, -1
    s_mov_b64 exec, s[72:73]
    s_add_u32 m0, s75, 1024
    s_mov_b32 s76, 10752
    buffer_load_dwordx4 v16, s[48:51], s76 offen lds
    s_mov_b64 exec, -1
    s_add_u32 m0, s74, 1024
    s_mov_b32 s76, 0
    buffer_load_dwordx4 v15, s[44:47], s76 offen lds
    s_mov_b64 exec, s[72:73]
    s_add_u32 m0, s75, 2048
    s_mov_b32 s76, 21504
    buffer_load_dwordx4 v16, s[48:51], s76 offen lds
    s_mov_b64 exec, -1
    s_mov_b64 exec, s[72:73]
    s_add_u32 m0, s75, 3072
    s_mov_b32 s76, 32256
    buffer_load_dwordx4 v16, s[48:51], s76 offen lds
    s_mov_b64 exec, -1
    s_add_u32 m0, s74, 16384
    s_mov_b32 s76, 128
    buffer_load_dwordx4 v14, s[44:47], s76 offen lds
    s_mov_b64 exec, s[72:73]
    s_add_u32 m0, s75, 32768
    s_mov_b32 s76, 172032
    buffer_load_dwordx4 v16, s[48:51], s76 offen lds
    s_mov_b64 exec, -1
    s_mov_b64 exec, s[72:73]
    s_add_u32 m0, s75, 33792
    s_mov_b32 s76, 182784
    buffer_load_dwordx4 v16, s[48:51], s76 offen lds
    s_mov_b64 exec, -1
    s_add_u32 m0, s74, 17408
    s_mov_b32 s76, 128
    buffer_load_dwordx4 v15, s[44:47], s76 offen lds
    s_mov_b64 exec, s[72:73]
    s_add_u32 m0, s75, 34816
    s_mov_b32 s76, 193536
    buffer_load_dwordx4 v16, s[48:51], s76 offen lds
    s_mov_b64 exec, -1
    s_mov_b64 exec, s[72:73]
    s_add_u32 m0, s75, 35840
    s_mov_b32 s76, 204288
    buffer_load_dwordx4 v16, s[48:51], s76 offen lds
    s_mov_b64 exec, -1
    s_lshl_b32 s80, s7, 4
    s_add_u32 s80, s80, s6
    s_cmp_ge_u32 s3, 4
    s_cbranch_scc1 pfh3
    s_mul_i32 s81, s80, 112
    s_mov_b32 s82, s3
    s_mul_i32 s82, s82, 28
    s_add_u32 s81, s81, s82
    v_add_u32 v224, s81, v0
    v_lshlrev_b32 v224, 7, v224
    v_cmp_gt_u32 vcc, 28, v0
    v_mov_b32 v225, 0x7fffff00
    s_nop 0
    v_cndmask_b32 v224, v225, v224, vcc
    buffer_load_dword v224, v224, s[44:47], 0 offen
    s_branch pfe3
pfh3:
    s_mul_i32 s81, s80, 74
    s_sub_u32 s82, s3, 4
    s_mul_i32 s82, s82, 19
    s_add_u32 s81, s81, s82
    v_add_u32 v224, s81, v0
    v_lshlrev_b32 v224, 7, v224
    v_cmp_gt_u32 vcc, 19, v0
    v_mov_b32 v225, 0x7fffff00
    s_nop 0
    v_cndmask_b32 v224, v225, v224, vcc
    buffer_load_dword v224, v224, s[48:51], 0 offen
pfe3:
    s_waitcnt vmcnt(7) lgkmcnt(0)
    s_barrier
    ds_read_b128 v[80:83], v8 offset:0
    ds_read_b64_tr_b16 v[84:85], v18 offset:0
    ds_read_b64_tr_b16 v[86:87], v18 offset:1024
    ds_read_b64_tr_b16 v[88:89], v19 offset:0
    ds_read_b64_tr_b16 v[90:91], v19 offset:1024
    ds_read_b64_tr_b16 v[92:93], v20 offset:0
    ds_read_b64_tr_b16 v[94:95], v20 offset:1024
    s_add_u32 m0, s74, 32768
    s_mov_b32 s76, 256
    buffer_load_dwordx4 v14, s[44:47], s76 offen lds
    s_mov_b64 exec, s[72:73]
    s_add_u32 m0, s75, 65536
    s_mov_b32 s76, 344064
    buffer_load_dwordx4 v16, s[48:51], s76 offen lds
    s_mov_b64 exec, -1
    ds_read_b128 v[96:99], v9 offset:0
    ds_read_b64_tr_b16 v[100:101], v18 offset:4096
    ds_read_b64_tr_b16 v[102:103], v18 offset:5120
    ds_read_b64_tr_b16 v[104:105], v19 offset:4096
    ds_read_b64_tr_b16 v[106:107], v19 offset:5120
    ds_read_b64_tr_b16 v[108:109], v20 offset:4096
    ds_read_b64_tr_b16 v[110:111], v20 offset:5120
    s_mov_b64 exec, s[72:73]
    s_add_u32 m0, s75, 66560
    s_mov_b32 s76, 354816
    buffer_load_dwordx4 v16, s[48:51], s76 offen lds
    s_mov_b64 exec, -1
    ds_read_b128 v[112:115], v10 offset:0
    ds_read_b64_tr_b16 v[116:117], v18 offset:8192
    ds_read_b64_tr_b16 v[118:119], v18 offset:9216
    ds_read_b64_tr_b16 v[120:121], v19 offset:8192
    ds_read_b64_tr_b16 v[122:123], v19 offset:9216
    ds_read_b64_tr_b16 v[124:125], v20 offset:8192
    ds_read_b64_tr_b16 v[126:127], v20 offset:9216
    s_add_u32 m0, s74, 33792
    s_mov_b32 s76, 256
    buffer_load_dwordx4 v15, s[44:47], s76 offen lds
    s_mov_b64 exec, s[72:73]
    s_add_u32 m0, s75, 67584
    s_mov_b32 s76, 365568
    buffer_load_dwordx4 v16, s[48:51], s76 offen lds
    s_mov_b64 exec, -1
    ds_read_b128 v[128:131], v11 offset:0
    ds_read_b64_tr_b16 v[132:133], v18 offset:12288
    ds_read_b64_tr_b16 v[134:135], v18 offset:13312
    ds_read_b64_tr_b16 v[136:137], v19 offset:12288
    ds_read_b64_tr_b16 v[138:139], v19 offset:13312
    ds_read_b64_tr_b16 v[140:141], v20 offset:12288
    ds_read_b64_tr_b16 v[142:143], v20 offset:13312
    s_mov_b64 exec, s[72:73]
    s_add_u32 m0, s75, 68608
    s_mov_b32 s76, 376320
    buffer_load_dwordx4 v16, s[48:51], s76 offen lds
    s_mov_b64 exec, -1
    s_waitcnt vmcnt(7) lgkmcnt(0)
    s_barrier
    ds_read_b128 v[144:147], v8 offset:16384
    ds_read_b64_tr_b16 v[148:149], v18 offset:32768
    ds_read_b64_tr_b16 v[150:151], v18 offset:33792
    ds_read_b64_tr_b16 v[152:153], v19 offset:32768
    ds_read_b64_tr_b16 v[154:155], v19 offset:33792
    ds_read_b64_tr_b16 v[156:157], v20 offset:32768
    ds_read_b64_tr_b16 v[158:159], v20 offset:33792
    v_mfma_f32_32x32x16_bf16 v[32:47], v[80:83], v[84:87], 0
    v_mfma_f32_32x32x16_bf16 v[48:63], v[80:83], v[88:91], 0
    v_mfma_f32_32x32x16_bf16 v[64:79], v[80:83], v[92:95], 0
    s_add_u32 m0, s74, 0
    s_mov_b32 s76, 384
    buffer_load_dwordx4 v14, s[44:47], s76 offen lds
    s_mov_b64 exec, s[72:73]
    s_add_u32 m0, s75, 0
    s_mov_b32 s76, 516096
    buffer_load_dwordx4 v16, s[48:51], s76 offen lds
    s_mov_b64 exec, -1
    ds_read_b128 v[160:163], v9 offset:16384
    ds_read_b64_tr_b16 v[164:165], v18 offset:36864
    ds_read_b64_tr_b16 v[166:167], v18 offset:37888
    ds_read_b64_tr_b16 v[168:169], v19 offset:36864
    ds_read_b64_tr_b16 v[170:171], v19 offset:37888
    ds_read_b64_tr_b16 v[172:173], v20 offset:36864
    ds_read_b64_tr_b16 v[174:175], v20 offset:37888
    v_mfma_f32_32x32x16_bf16 v[32:47], v[96:99], v[100:103], v[32:47]
    v_mfma_f32_32x32x16_bf16 v[48:63], v[96:99], v[104:107], v[48:63]
    v_mfma_f32_32x32x16_bf16 v[64:79], v[96:99], v[108:111], v[64:79]
    s_mov_b64 exec, s[72:73]
    s_add_u32 m0, s75, 1024
    s_mov_b32 s76, 526848
    buffer_load_dwordx4 v16, s[48:51], s76 offen lds
    s_mov_b64 exec, -1
    ds_read_b128 v[176:179], v10 offset:16384
    ds_read_b64_tr_b16 v[180:181], v18 offset:40960
    ds_read_b64_tr_b16 v[182:183], v18 offset:41984
    ds_read_b64_tr_b16 v[184:185], v19 offset:40960
    ds_read_b64_tr_b16 v[186:187], v19 offset:41984
    ds_read_b64_tr_b16 v[188:189], v20 offset:40960
    ds_read_b64_tr_b16 v[190:191], v20 offset:41984
    v_mfma_f32_32x32x16_bf16 v[32:47], v[112:115], v[116:119], v[32:47]
    v_mfma_f32_32x32x16_bf16 v[48:63], v[112:115], v[120:123], v[48:63]
    v_mfma_f32_32x32x16_bf16 v[64:79], v[112:115], v[124:127], v[64:79]
    s_add_u32 m0, s74, 1024
    s_mov_b32 s76, 384
    buffer_load_dwordx4 v15, s[44:47], s76 offen lds
    s_mov_b64 exec, s[72:73]
    s_add_u32 m0, s75, 2048
    s_mov_b32 s76, 537600
    buffer_load_dwordx4 v16, s[48:51], s76 offen lds
    s_mov_b64 exec, -1
    ds_read_b128 v[192:195], v11 offset:16384
    ds_read_b64_tr_b16 v[196:197], v18 offset:45056
    ds_read_b64_tr_b16 v[198:199], v18 offset:46080
    ds_read_b64_tr_b16 v[200:201], v19 offset:45056
    ds_read_b64_tr_b16 v[202:203], v19 offset:46080
    ds_read_b64_tr_b16 v[204:205], v20 offset:45056
    ds_read_b64_tr_b16 v[206:207], v20 offset:46080
    v_mfma_f32_32x32x16_bf16 v[32:47], v[128:131], v[132:135], v[32:47]
    v_mfma_f32_32x32x16_bf16 v[48:63], v[128:131], v[136:139], v[48:63]
    v_mfma_f32_32x32x16_bf16 v[64:79], v[128:131], v[140:143], v[64:79]
    s_mov_b64 exec, s[72:73]
    s_add_u32 m0, s75, 3072
    s_mov_b32 s76, 548352
    buffer_load_dwordx4 v16, s[48:51], s76 offen lds
    s_mov_b64 exec, -1
    s_waitcnt vmcnt(6) lgkmcnt(0)
    s_barrier
    ds_read_b128 v[80:83], v8 offset:32768
    ds_read_b64_tr_b16 v[84:85], v21 offset:0
    ds_read_b64_tr_b16 v[86:87], v21 offset:1024
    ds_read_b64_tr_b16 v[88:89], v22 offset:0
    ds_read_b64_tr_b16 v[90:91], v22 offset:1024
    ds_read_b64_tr_b16 v[92:93], v23 offset:0
    ds_read_b64_tr_b16 v[94:95], v23 offset:1024
    v_mfma_f32_32x32x16_bf16 v[32:47], v[144:147], v[148:151], v[32:47]
    v_mfma_f32_32x32x16_bf16 v[48:63], v[144:147], v[152:155], v[48:63]
    v_mfma_f32_32x32x16_bf16 v[64:79], v[144:147], v[156:159], v[64:79]
    s_add_u32 m0, s74, 16384
    s_mov_b32 s76, 512
    buffer_load_dwordx4 v14, s[44:47], s76 offen lds
    s_mov_b64 exec, s[72:73]
    s_add_u32 m0, s75, 32768
    s_mov_b32 s76, 688128
    buffer_load_dwordx4 v16, s[48:51], s76 offen lds
    s_mov_b64 exec, -1
    ds_read_b128 v[96:99], v9 offset:32768
    ds_read_b64_tr_b16 v[100:101], v21 offset:4096
    ds_read_b64_tr_b16 v[102:103], v21 offset:5120
    ds_read_b64_tr_b16 v[104:105], v22 offset:4096
    ds_read_b64_tr_b16 v[106:107], v22 offset:5120
    ds_read_b64_tr_b16 v[108:109], v23 offset:4096
    ds_read_b64_tr_b16 v[110:111], v23 offset:5120
    v_mfma_f32_32x32x16_bf16 v[32:47], v[160:163], v[164:167], v[32:47]
    v_mfma_f32_32x32x16_bf16 v[48:63], v[160:163], v[168:171], v[48:63]
    v_mfma_f32_32x32x16_bf16 v[64:79], v[160:163], v[172:175], v[64:79]
    s_mov_b64 exec, s[72:73]
    s_add_u32 m0, s75, 33792
    s_mov_b32 s76, 698880
    buffer_load_dwordx4 v16, s[48:51], s76 offen lds
    s_mov_b64 exec, -1
    ds_read_b128 v[112:115], v10 offset:32768
    ds_read_b64_tr_b16 v[116:117], v21 offset:8192
    ds_read_b64_tr_b16 v[118:119], v21 offset:9216
    ds_read_b64_tr_b16 v[120:121], v22 offset:8192
    ds_read_b64_tr_b16 v[122:123], v22 offset:9216
    ds_read_b64_tr_b16 v[124:125], v23 offset:8192
    ds_read_b64_tr_b16 v[126:127], v23 offset:9216
    v_mfma_f32_32x32x16_bf16 v[32:47], v[176:179], v[180:183], v[32:47]
    v_mfma_f32_32x32x16_bf16 v[48:63], v[176:179], v[184:187], v[48:63]
    v_mfma_f32_32x32x16_bf16 v[64:79], v[176:179], v[188:191], v[64:79]
    s_add_u32 m0, s74, 17408
    s_mov_b32 s76, 512
    buffer_load_dwordx4 v15, s[44:47], s76 offen lds
    s_mov_b64 exec, s[72:73]
    s_add_u32 m0, s75, 34816
    s_mov_b32 s76, 709632
    buffer_load_dwordx4 v16, s[48:51], s76 offen lds
    s_mov_b64 exec, -1
    ds_read_b128 v[128:131], v11 offset:32768
    ds_read_b64_tr_b16 v[132:133], v21 offset:12288
    ds_read_b64_tr_b16 v[134:135], v21 offset:13312
    ds_read_b64_tr_b16 v[136:137], v22 offset:12288
    ds_read_b64_tr_b16 v[138:139], v22 offset:13312
    ds_read_b64_tr_b16 v[140:141], v23 offset:12288
    ds_read_b64_tr_b16 v[142:143], v23 offset:13312
    v_mfma_f32_32x32x16_bf16 v[32:47], v[192:195], v[196:199], v[32:47]
    v_mfma_f32_32x32x16_bf16 v[48:63], v[192:195], v[200:203], v[48:63]
    v_mfma_f32_32x32x16_bf16 v[64:79], v[192:195], v[204:207], v[64:79]
    s_mov_b64 exec, s[72:73]
    s_add_u32 m0, s75, 35840
    s_mov_b32 s76, 720384
    buffer_load_dwordx4 v16, s[48:51], s76 offen lds
    s_mov_b64 exec, -1
    s_waitcnt vmcnt(6) lgkmcnt(0)
    s_barrier
    ds_read_b128 v[144:147], v8 offset:0
    ds_read_b64_tr_b16 v[148:149], v18 offset:0
    ds_read_b64_tr_b16 v[150:151], v18 offset:1024
    ds_read_b64_tr_b16 v[152:153], v19 offset:0
    ds_read_b64_tr_b16 v[154:155], v19 offset:1024
    ds_read_b64_tr_b16 v[156:157], v20 offset:0
    ds_read_b64_tr_b16 v[158:159], v20 offset:1024
    v_mfma_f32_32x32x16_bf16 v[32:47], v[80:83], v[84:87], v[32:47]
    v_mfma_f32_32x32x16_bf16 v[48:63], v[80:83], v[88:91], v[48:63]
    v_mfma_f32_32x32x16_bf16 v[64:79], v[80:83], v[92:95], v[64:79]
    s_add_u32 m0, s74, 32768
    s_mov_b32 s76, 640
    buffer_load_dwordx4 v14, s[44:47], s76 offen lds
    s_mov_b64 exec, s[72:73]
    s_add_u32 m0, s75, 65536
    s_mov_b32 s76, 860160
    buffer_load_dwordx4 v16, s[48:51], s76 offen lds
    s_mov_b64 exec, -1
    ds_read_b128 v[160:163], v9 offset:0
    ds_read_b64_tr_b16 v[164:165], v18 offset:4096
    ds_read_b64_tr_b16 v[166:167], v18 offset:5120
    ds_read_b64_tr_b16 v[168:169], v19 offset:4096
    ds_read_b64_tr_b16 v[170:171], v19 offset:5120
    ds_read_b64_tr_b16 v[172:173], v20 offset:4096
    ds_read_b64_tr_b16 v[174:175], v20 offset:5120
    v_mfma_f32_32x32x16_bf16 v[32:47], v[96:99], v[100:103], v[32:47]
    v_mfma_f32_32x32x16_bf16 v[48:63], v[96:99], v[104:107], v[48:63]
    v_mfma_f32_32x32x16_bf16 v[64:79], v[96:99], v[108:111], v[64:79]
    s_mov_b64 exec, s[72:73]
    s_add_u32 m0, s75, 66560
    s_mov_b32 s76, 870912
    buffer_load_dwordx4 v16, s[48:51], s76 offen lds
    s_mov_b64 exec, -1
    ds_read_b128 v[176:179], v10 offset:0
    ds_read_b64_tr_b16 v[180:181], v18 offset:8192
    ds_read_b64_tr_b16 v[182:183], v18 offset:9216
    ds_read_b64_tr_b16 v[184:185], v19 offset:8192
    ds_read_b64_tr_b16 v[186:187], v19 offset:9216
    ds_read_b64_tr_b16 v[188:189], v20 offset:8192
    ds_read_b64_tr_b16 v[190:191], v20 offset:9216
    v_mfma_f32_32x32x16_bf16 v[32:47], v[112:115], v[116:119], v[32:47]
    v_mfma_f32_32x32x16_bf16 v[48:63], v[112:115], v[120:123], v[48:63]
    v_mfma_f32_32x32x16_bf16 v[64:79], v[112:115], v[124:127], v[64:79]
    s_add_u32 m0, s74, 33792
    s_mov_b32 s76, 640
    buffer_load_dwordx4 v15, s[44:47], s76 offen lds
    s_mov_b64 exec, s[72:73]
    s_add_u32 m0, s75, 67584
    s_mov_b32 s76, 881664
    buffer_load_dwordx4 v16, s[48:51], s76 offen lds
    s_mov_b64 exec, -1
    ds_read_b128 v[192:195], v11 offset:0
    ds_read_b64_tr_b16 v[196:197], v18 offset:12288
    ds_read_b64_tr_b16 v[198:199], v18 offset:13312
    ds_read_b64_tr_b16 v[200:201], v19 offset:12288
    ds_read_b64_tr_b16 v[202:203], v19 offset:13312
    ds_read_b64_tr_b16 v[204:205], v20 offset:12288
    ds_read_b64_tr_b16 v[206:207], v20 offset:13312
    v_mfma_f32_32x32x16_bf16 v[32:47], v[128:131], v[132:135], v[32:47]
    v_mfma_f32_32x32x16_bf16 v[48:63], v[128:131], v[136:139], v[48:63]
    v_mfma_f32_32x32x16_bf16 v[64:79], v[128:131], v[140:143], v[64:79]
    s_mov_b64 exec, s[72:73]
    s_add_u32 m0, s75, 68608
    s_mov_b32 s76, 892416
    buffer_load_dwordx4 v16, s[48:51], s76 offen lds
    s_mov_b64 exec, -1
    s_waitcnt vmcnt(6) lgkmcnt(0)
    s_barrier
    ds_read_b128 v[80:83], v8 offset:16384
    ds_read_b64_tr_b16 v[84:85], v18 offset:32768
    ds_read_b64_tr_b16 v[86:87], v18 offset:33792
    ds_read_b64_tr_b16 v[88:89], v19 offset:32768
    ds_read_b64_tr_b16 v[90:91], v19 offset:33792
    ds_read_b64_tr_b16 v[92:93], v20 offset:32768
    ds_read_b64_tr_b16 v[94:95], v20 offset:33792
    v_mfma_f32_32x32x16_bf16 v[32:47], v[144:147], v[148:151], v[32:47]
    v_mfma_f32_32x32x16_bf16 v[48:63], v[144:147], v[152:155], v[48:63]
    v_mfma_f32_32x32x16_bf16 v[64:79], v[144:147], v[156:159], v[64:79]
    s_add_u32 m0, s74, 0
    s_mov_b32 s76, 768
    buffer_load_dwordx4 v14, s[44:47], s76 offen lds
    s_mov_b64 exec, s[72:73]
    s_add_u32 m0, s75, 0
    s_mov_b32 s76, 1032192
    buffer_load_dwordx4 v16, s[48:51], s76 offen lds
    s_mov_b64 exec, -1
    ds_read_b128 v[96:99], v9 offset:16384
    ds_read_b64_tr_b16 v[100:101], v18 offset:36864
    ds_read_b64_tr_b16 v[102:103], v18 offset:37888
    ds_read_b64_tr_b16 v[104:105], v19 offset:36864
    ds_read_b64_tr_b16 v[106:107], v19 offset:37888
    ds_read_b64_tr_b16 v[108:109], v20 offset:36864
    ds_read_b64_tr_b16 v[110:111], v20 offset:37888
    v_mfma_f32_32x32x16_bf16 v[32:47], v[160:163], v[164:167], v[32:47]
    v_mfma_f32_32x32x16_bf16 v[48:63], v[160:163], v[168:171], v[48:63]
    v_mfma_f32_32x32x16_bf16 v[64:79], v[160:163], v[172:175], v[64:79]
    s_mov_b64 exec, s[72:73]
    s_add_u32 m0, s75, 1024
    s_mov_b32 s76, 1042944
    buffer_load_dwordx4 v16, s[48:51], s76 offen lds
    s_mov_b64 exec, -1
    ds_read_b128 v[112:115], v10 offset:16384
    ds_read_b64_tr_b16 v[116:117], v18 offset:40960
    ds_read_b64_tr_b16 v[118:119], v18 offset:41984
    ds_read_b64_tr_b16 v[120:121], v19 offset:40960
    ds_read_b64_tr_b16 v[122:123], v19 offset:41984
    ds_read_b64_tr_b16 v[124:125], v20 offset:40960
    ds_read_b64_tr_b16 v[126:127], v20 offset:41984
    v_mfma_f32_32x32x16_bf16 v[32:47], v[176:179], v[180:183], v[32:47]
    v_mfma_f32_32x32x16_bf16 v[48:63], v[176:179], v[184:187], v[48:63]
    v_mfma_f32_32x32x16_bf16 v[64:79], v[176:179], v[188:191], v[64:79]
    s_add_u32 m0, s74, 1024
    s_mov_b32 s76, 768
    buffer_load_dwordx4 v15, s[44:47], s76 offen lds
    s_mov_b64 exec, s[72:73]
    s_add_u32 m0, s75, 2048
    s_mov_b32 s76, 1053696
    buffer_load_dwordx4 v16, s[48:51], s76 offen lds
    s_mov_b64 exec, -1
    ds_read_b128 v[128:131], v11 offset:16384
    ds_read_b64_tr_b16 v[132:133], v18 offset:45056
    ds_read_b64_tr_b16 v[134:135], v18 offset:46080
    ds_read_b64_tr_b16 v[136:137], v19 offset:45056
    ds_read_b64_tr_b16 v[138:139], v19 offset:46080
    ds_read_b64_tr_b16 v[140:141], v20 offset:45056
    ds_read_b64_tr_b16 v[142:143], v20 offset:46080
    v_mfma_f32_32x32x16_bf16 v[32:47], v[192:195], v[196:199], v[32:47]
    v_mfma_f32_32x32x16_bf16 v[48:63], v[192:195], v[200:203], v[48:63]
    v_mfma_f32_32x32x16_bf16 v[64:79], v[192:195], v[204:207], v[64:79]
    s_mov_b64 exec, s[72:73]
    s_add_u32 m0, s75, 3072
    s_mov_b32 s76, 1064448
    buffer_load_dwordx4 v16, s[48:51], s76 offen lds
    s_mov_b64 exec, -1
    s_waitcnt vmcnt(6) lgkmcnt(0)
    s_barrier
    ds_read_b128 v[144:147], v8 offset:32768
    ds_read_b64_tr_b16 v[148:149], v21 offset:0
    ds_read_b64_tr_b16 v[150:151], v21 offset:1024
    ds_read_b64_tr_b16 v[152:153], v22 offset:0
    ds_read_b64_tr_b16 v[154:155], v22 offset:1024
    ds_read_b64_tr_b16 v[156:157], v23 offset:0
    ds_read_b64_tr_b16 v[158:159], v23 offset:1024
    v_mfma_f32_32x32x16_bf16 v[32:47], v[80:83], v[84:87], v[32:47]
    v_mfma_f32_32x32x16_bf16 v[48:63], v[80:83], v[88:91], v[48:63]
    v_mfma_f32_32x32x16_bf16 v[64:79], v[80:83], v[92:95], v[64:79]
    ds_read_b128 v[160:163], v9 offset:32768
    ds_read_b64_tr_b16 v[164:165], v21 offset:4096
    ds_read_b64_tr_b16 v[166:167], v21 offset:5120
    ds_read_b64_tr_b16 v[168:169], v22 offset:4096
    ds_read_b64_tr_b16 v[170:171], v22 offset:5120
    ds_read_b64_tr_b16 v[172:173], v23 offset:4096
    ds_read_b64_tr_b16 v[174:175], v23 offset:5120
    v_mfma_f32_32x32x16_bf16 v[32:47], v[96:99], v[100:103], v[32:47]
    v_mfma_f32_32x32x16_bf16 v[48:63], v[96:99], v[104:107], v[48:63]
    v_mfma_f32_32x32x16_bf16 v[64:79], v[96:99], v[108:111], v[64:79]
    ds_read_b128 v[176:179], v10 offset:32768
    ds_read_b64_tr_b16 v[180:181], v21 offset:8192
    ds_read_b64_tr_b16 v[182:183], v21 offset:9216
    ds_read_b64_tr_b16 v[184:185], v22 offset:8192
    ds_read_b64_tr_b16 v[186:187], v22 offset:9216
    ds_read_b64_tr_b16 v[188:189], v23 offset:8192
    ds_read_b64_tr_b16 v[190:191], v23 offset:9216
    v_mfma_f32_32x32x16_bf16 v[32:47], v[112:115], v[116:119], v[32:47]
    v_mfma_f32_32x32x16_bf16 v[48:63], v[112:115], v[120:123], v[48:63]
    v_mfma_f32_32x32x16_bf16 v[64:79], v[112:115], v[124:127], v[64:79]
    ds_read_b128 v[192:195], v11 offset:32768
    ds_read_b64_tr_b16 v[196:197], v21 offset:12288
    ds_read_b64_tr_b16 v[198:199], v21 offset:13312
    ds_read_b64_tr_b16 v[200:201], v22 offset:12288
    ds_read_b64_tr_b16 v[202:203], v22 offset:13312
    ds_read_b64_tr_b16 v[204:205], v23 offset:12288
    ds_read_b64_tr_b16 v[206:207], v23 offset:13312
    v_mfma_f32_32x32x16_bf16 v[32:47], v[128:131], v[132:135], v[32:47]
    v_mfma_f32_32x32x16_bf16 v[48:63], v[128:131], v[136:139], v[48:63]
    v_mfma_f32_32x32x16_bf16 v[64:79], v[128:131], v[140:143], v[64:79]
    s_waitcnt vmcnt(0) lgkmcnt(0)
    s_barrier
    ds_read_b128 v[80:83], v8 offset:0
    ds_read_b64_tr_b16 v[84:85], v18 offset:0
    ds_read_b64_tr_b16 v[86:87], v18 offset:1024
    ds_read_b64_tr_b16 v[88:89], v19 offset:0
    ds_read_b64_tr_b16 v[90:91], v19 offset:1024
    ds_read_b64_tr_b16 v[92:93], v20 offset:0
    ds_read_b64_tr_b16 v[94:95], v20 offset:1024
    v_mfma_f32_32x32x16_bf16 v[32:47], v[144:147], v[148:151], v[32:47]
    v_mfma_f32_32x32x16_bf16 v[48:63], v[144:147], v[152:155], v[48:63]
    v_mfma_f32_32x32x16_bf16 v[64:79], v[144:147], v[156:159], v[64:79]
    ds_read_b128 v[96:99], v9 offset:0
    ds_read_b64_tr_b16 v[100:101], v18 offset:4096
    ds_read_b64_tr_b16 v[102:103], v18 offset:5120
    ds_read_b64_tr_b16 v[104:105], v19 offset:4096
    ds_read_b64_tr_b16 v[106:107], v19 offset:5120
    ds_read_b64_tr_b16 v[108:109], v20 offset:4096
    ds_read_b64_tr_b16 v[110:111], v20 offset:5120
    v_mfma_f32_32x32x16_bf16 v[32:47], v[160:163], v[164:167], v[32:47]
    v_mfma_f32_32x32x16_bf16 v[48:63], v[160:163], v[168:171], v[48:63]
    v_mfma_f32_32x32x16_bf16 v[64:79], v[160:163], v[172:175], v[64:79]
    ds_read_b128 v[112:115], v10 offset:0
    ds_read_b64_tr_b16 v[116:117], v18 offset:8192
    ds_read_b64_tr_b16 v[118:119], v18 offset:9216
    ds_read_b64_tr_b16 v[120:121], v19 offset:8192
    ds_read_b64_tr_b16 v[122:123], v19 offset:9216
    ds_read_b64_tr_b16 v[124:125], v20 offset:8192
    ds_read_b64_tr_b16 v[126:127], v20 offset:9216
    v_mfma_f32_32x32x16_bf16 v[32:47], v[176:179], v[180:183], v[32:47]
    v_mfma_f32_32x32x16_bf16 v[48:63], v[176:179], v[184:187], v[48:63]
    v_mfma_f32_32x32x16_bf16 v[64:79], v[176:179], v[188:191], v[64:79]
    ds_read_b128 v[128:131], v11 offset:0
    ds_read_b64_tr_b16 v[132:133], v18 offset:12288
    ds_read_b64_tr_b16 v[134:135], v18 offset:13312
    ds_read_b64_tr_b16 v[136:137], v19 offset:12288
    ds_read_b64_tr_b16 v[138:139], v19 offset:13312
    ds_read_b64_tr_b16 v[140:141], v20 offset:12288
    ds_read_b64_tr_b16 v[142:143], v20 offset:13312
    v_mfma_f32_32x32x16_bf16 v[32:47], v[192:195], v[196:199], v[32:47]
    v_mfma_f32_32x32x16_bf16 v[48:63], v[192:195], v[200:203], v[48:63]
    v_mfma_f32_32x32x16_bf16 v[64:79], v[192:195], v[204:207], v[64:79]
    s_waitcnt lgkmcnt(0)
    v_mfma_f32_32x32x16_bf16 v[32:47], v[80:83], v[84:87], v[32:47]
    v_mfma_f32_32x32x16_bf16 v[48:63], v[80:83], v[88:91], v[48:63]
    v_mfma_f32_32x32x16_bf16 v[64:79], v[80:83], v[92:95], v[64:79]
    v_mfma_f32_32x32x16_bf16 v[32:47], v[96:99], v[100:103], v[32:47]
    v_mfma_f32_32x32x16_bf16 v[48:63], v[96:99], v[104:107], v[48:63]
    v_mfma_f32_32x32x16_bf16 v[64:79], v[96:99], v[108:111], v[64:79]
    v_mfma_f32_32x32x16_bf16 v[32:47], v[112:115], v[116:119], v[32:47]
    v_mfma_f32_32x32x16_bf16 v[48:63], v[112:115], v[120:123], v[48:63]
    v_mfma_f32_32x32x16_bf16 v[64:79], v[112:115], v[124:127], v[64:79]
    v_mfma_f32_32x32x16_bf16 v[32:47], v[128:131], v[132:135], v[32:47]
    v_mfma_f32_32x32x16_bf16 v[48:63], v[128:131], v[136:139], v[48:63]
    v_mfma_f32_32x32x16_bf16 v[64:79], v[128:131], v[140:143], v[64:79]
    s_branch k1_epi
k1_epi:
    s_nop 15
    s_lshl_b32 s79, s6, 2
    s_add_u32 s79, s79, s9
    v_lshlrev_b32 v6, 4, v0
    v_cmp_le_u32 vcc, 32, v0
    s_mov_b64 s[80:81], vcc
    v_cmp_eq_u32 vcc, 28, v1
    s_mov_b64 s[82:83], vcc
    v_cmp_lt_u32 vcc, 28, v1
    s_mov_b64 s[84:85], vcc
    s_add_u32 s86, s77, 0
    s_lshl_b32 s87, s86, 6
    s_add_u32 s87, s87, s79
    s_lshl_b32 s87, s87, 11
    s_cmp_ge_u32 s86, 16
    s_cbranch_scc1 k1_e0n
    v_mul_f32 v32, 0x3e8b97f6, v32
    v_mul_f32 v33, 0x3e8b97f6, v33
    v_mul_f32 v34, 0x3e8b97f6, v34
    v_mul_f32 v35, 0x3e8b97f6, v35
    v_mul_f32 v36, 0x3e8b97f6, v36
    v_mul_f32 v37, 0x3e8b97f6, v37
    v_mul_f32 v38, 0x3e8b97f6, v38
    v_mul_f32 v39, 0x3e8b97f6, v39
    v_mul_f32 v40, 0x3e8b97f6, v40
    v_mul_f32 v41, 0x3e8b97f6, v41
    v_mul_f32 v42, 0x3e8b97f6, v42
    v_mul_f32 v43, 0x3e8b97f6, v43
    v_mul_f32 v44, 0x3e8b97f6, v44
    v_mul_f32 v45, 0x3e8b97f6, v45
    v_mul_f32 v46, 0x3e8b97f6, v46
    v_mul_f32 v47, 0x3e8b97f6, v47
k1_e0n:
    v_cvt_pk_bf16_f32 v32, v32, v33
    v_cvt_pk_bf16_f32 v33, v34, v35
    v_cvt_pk_bf16_f32 v34, v36, v37
    v_cvt_pk_bf16_f32 v35, v38, v39
    v_cvt_pk_bf16_f32 v36, v40, v41
    v_cvt_pk_bf16_f32 v37, v42, v43
    v_cvt_pk_bf16_f32 v38, v44, v45
    v_cvt_pk_bf16_f32 v39, v46, v47
    s_cmp_ge_u32 s86, 32
    s_cbranch_scc1 k1_e0v
    s_cmp_ge_u32 s86, 16
    s_cselect_b32 s88, 0x3f80, 0
    v_mov_b32 v7, s88
    v_cndmask_b32 v38, v38, v7, s[80:81]
    v_cndmask_b32 v39, v39, 0, s[80:81]
    s_branch k1_e0s
k1_e0v:
    v_mov_b32 v7, 0x3f803f80
    v_cndmask_b32 v32, v32, v7, s[82:83]
    v_cndmask_b32 v32, v32, 0, s[84:85]
    v_cndmask_b32 v33, v33, v7, s[82:83]
    v_cndmask_b32 v33, v33, 0, s[84:85]
    v_cndmask_b32 v34, v34, v7, s[82:83]
    v_cndmask_b32 v34, v34, 0, s[84:85]
    v_cndmask_b32 v35, v35, v7, s[82:83]
    v_cndmask_b32 v35, v35, 0, s[84:85]
    v_cndmask_b32 v36, v36, v7, s[82:83]
    v_cndmask_b32 v36, v36, 0, s[84:85]
    v_cndmask_b32 v37, v37, v7, s[82:83]
    v_cndmask_b32 v37, v37, 0, s[84:85]
    v_cndmask_b32 v38, v38, v7, s[82:83]
    v_cndmask_b32 v38, v38, 0, s[84:85]
    v_cndmask_b32 v39, v39, v7, s[82:83]
    v_cndmask_b32 v39, v39, 0, s[84:85]
k1_e0s:
    buffer_store_dwordx4 v[32:35], v6, s[56:59], s87 offen
    buffer_store_dwordx4 v[36:39], v6, s[56:59], s87 offen offset:1024
    s_add_u32 s86, s77, 1
    s_lshl_b32 s87, s86, 6
    s_add_u32 s87, s87, s79
    s_lshl_b32 s87, s87, 11
    s_cmp_ge_u32 s86, 16
    s_cbranch_scc1 k1_e1n
    v_mul_f32 v48, 0x3e8b97f6, v48
    v_mul_f32 v49, 0x3e8b97f6, v49
    v_mul_f32 v50, 0x3e8b97f6, v50
    v_mul_f32 v51, 0x3e8b97f6, v51
    v_mul_f32 v52, 0x3e8b97f6, v52
    v_mul_f32 v53, 0x3e8b97f6, v53
    v_mul_f32 v54, 0x3e8b97f6, v54
    v_mul_f32 v55, 0x3e8b97f6, v55
    v_mul_f32 v56, 0x3e8b97f6, v56
    v_mul_f32 v57, 0x3e8b97f6, v57
    v_mul_f32 v58, 0x3e8b97f6, v58
    v_mul_f32 v59, 0x3e8b97f6, v59
    v_mul_f32 v60, 0x3e8b97f6, v60
    v_mul_f32 v61, 0x3e8b97f6, v61
    v_mul_f32 v62, 0x3e8b97f6, v62
    v_mul_f32 v63, 0x3e8b97f6, v63
k1_e1n:
    v_cvt_pk_bf16_f32 v48, v48, v49
    v_cvt_pk_bf16_f32 v49, v50, v51
    v_cvt_pk_bf16_f32 v50, v52, v53
    v_cvt_pk_bf16_f32 v51, v54, v55
    v_cvt_pk_bf16_f32 v52, v56, v57
    v_cvt_pk_bf16_f32 v53, v58, v59
    v_cvt_pk_bf16_f32 v54, v60, v61
    v_cvt_pk_bf16_f32 v55, v62, v63
    s_cmp_ge_u32 s86, 32
    s_cbranch_scc1 k1_e1v
    s_cmp_ge_u32 s86, 16
    s_cselect_b32 s88, 0x3f80, 0
    v_mov_b32 v7, s88
    v_cndmask_b32 v54, v54, v7, s[80:81]
    v_cndmask_b32 v55, v55, 0, s[80:81]
    s_branch k1_e1s
k1_e1v:
    v_mov_b32 v7, 0x3f803f80
    v_cndmask_b32 v48, v48, v7, s[82:83]
    v_cndmask_b32 v48, v48, 0, s[84:85]
    v_cndmask_b32 v49, v49, v7, s[82:83]
    v_cndmask_b32 v49, v49, 0, s[84:85]
    v_cndmask_b32 v50, v50, v7, s[82:83]
    v_cndmask_b32 v50, v50, 0, s[84:85]
    v_cndmask_b32 v51, v51, v7, s[82:83]
    v_cndmask_b32 v51, v51, 0, s[84:85]
    v_cndmask_b32 v52, v52, v7, s[82:83]
    v_cndmask_b32 v52, v52, 0, s[84:85]
    v_cndmask_b32 v53, v53, v7, s[82:83]
    v_cndmask_b32 v53, v53, 0, s[84:85]
    v_cndmask_b32 v54, v54, v7, s[82:83]
    v_cndmask_b32 v54, v54, 0, s[84:85]
    v_cndmask_b32 v55, v55, v7, s[82:83]
    v_cndmask_b32 v55, v55, 0, s[84:85]
k1_e1s:
    buffer_store_dwordx4 v[48:51], v6, s[56:59], s87 offen
    buffer_store_dwordx4 v[52:55], v6, s[56:59], s87 offen offset:1024
    s_add_u32 s86, s77, 2
    s_lshl_b32 s87, s86, 6
    s_add_u32 s87, s87, s79
    s_lshl_b32 s87, s87, 11
    s_cmp_ge_u32 s86, 16
    s_cbranch_scc1 k1_e2n
    v_mul_f32 v64, 0x3e8b97f6, v64
    v_mul_f32 v65, 0x3e8b97f6, v65
    v_mul_f32 v66, 0x3e8b97f6, v66
    v_mul_f32 v67, 0x3e8b97f6, v67
    v_mul_f32 v68, 0x3e8b97f6, v68
    v_mul_f32 v69, 0x3e8b97f6, v69
    v_mul_f32 v70, 0x3e8b97f6, v70
    v_mul_f32 v71, 0x3e8b97f6, v71
    v_mul_f32 v72, 0x3e8b97f6, v72
    v_mul_f32 v73, 0x3e8b97f6, v73
    v_mul_f32 v74, 0x3e8b97f6, v74
    v_mul_f32 v75, 0x3e8b97f6, v75
    v_mul_f32 v76, 0x3e8b97f6, v76
    v_mul_f32 v77, 0x3e8b97f6, v77
    v_mul_f32 v78, 0x3e8b97f6, v78
    v_mul_f32 v79, 0x3e8b97f6, v79
k1_e2n:
    v_cvt_pk_bf16_f32 v64, v64, v65
    v_cvt_pk_bf16_f32 v65, v66, v67
    v_cvt_pk_bf16_f32 v66, v68, v69
    v_cvt_pk_bf16_f32 v67, v70, v71
    v_cvt_pk_bf16_f32 v68, v72, v73
    v_cvt_pk_bf16_f32 v69, v74, v75
    v_cvt_pk_bf16_f32 v70, v76, v77
    v_cvt_pk_bf16_f32 v71, v78, v79
    s_cmp_ge_u32 s86, 32
    s_cbranch_scc1 k1_e2v
    s_cmp_ge_u32 s86, 16
    s_cselect_b32 s88, 0x3f80, 0
    v_mov_b32 v7, s88
    v_cndmask_b32 v70, v70, v7, s[80:81]
    v_cndmask_b32 v71, v71, 0, s[80:81]
    s_branch k1_e2s
k1_e2v:
    v_mov_b32 v7, 0x3f803f80
    v_cndmask_b32 v64, v64, v7, s[82:83]
    v_cndmask_b32 v64, v64, 0, s[84:85]
    v_cndmask_b32 v65, v65, v7, s[82:83]
    v_cndmask_b32 v65, v65, 0, s[84:85]
    v_cndmask_b32 v66, v66, v7, s[82:83]
    v_cndmask_b32 v66, v66, 0, s[84:85]
    v_cndmask_b32 v67, v67, v7, s[82:83]
    v_cndmask_b32 v67, v67, 0, s[84:85]
    v_cndmask_b32 v68, v68, v7, s[82:83]
    v_cndmask_b32 v68, v68, 0, s[84:85]
    v_cndmask_b32 v69, v69, v7, s[82:83]
    v_cndmask_b32 v69, v69, 0, s[84:85]
    v_cndmask_b32 v70, v70, v7, s[82:83]
    v_cndmask_b32 v70, v70, 0, s[84:85]
    v_cndmask_b32 v71, v71, v7, s[82:83]
    v_cndmask_b32 v71, v71, 0, s[84:85]
k1_e2s:
    buffer_store_dwordx4 v[64:67], v6, s[56:59], s87 offen
    buffer_store_dwordx4 v[68:71], v6, s[56:59], s87 offen offset:1024
    s_waitcnt vmcnt(0)
    s_endpgm
k1_u:
    s_mov_b32 s44, s16
    s_mov_b32 s45, s17
    s_mov_b32 s46, 0x1c0000
    s_mov_b32 s47, 0x20000
    s_mov_b32 s48, s22
    s_mov_b32 s49, s23
    s_mov_b32 s50, 0x62000
    s_mov_b32 s51, 0x20000
    s_mov_b32 s52, s24
    s_mov_b32 s53, s25
    s_mov_b32 s54, 0x62000
    s_mov_b32 s55, 0x20000
    s_add_u32 s56, s42, 0x600000
    s_addc_u32 s57, s43, 0
    s_mov_b32 s58, 0x380000
    s_mov_b32 s59, 0x20000
    s_mov_b32 s60, s18
    s_mov_b32 s61, s19
    s_mov_b32 s62, 0x380
    s_mov_b32 s63, 0x20000
    s_mov_b32 s64, s20
    s_mov_b32 s65, s21
    s_mov_b32 s66, 0x380
    s_mov_b32 s67, 0x20000
    s_mov_b32 s68, s30
    s_mov_b32 s69, s31
    s_mov_b32 s70, 0x380
    s_mov_b32 s71, 0x20000
    s_sub_u32 s7, s7, 8
    s_lshl_b32 s11, s7, 6
    s_lshl_b32 s12, s10, 5
    s_add_u32 s12, s12, s11
    v_add_u32 v25, s12, v1
    v_lshlrev_b32 v26, 1, v25
    buffer_load_ushort v116, v26, s[60:63], 0 offen
    buffer_load_ushort v117, v26, s[64:67], 0 offen
    buffer_load_ushort v118, v26, s[68:71], 0 offen
    s_lshl_b32 s13, s6, 7
    s_lshr_b32 s14, s3, 1
    s_lshl_b32 s14, s14, 5
    s_add_u32 s13, s13, s14
    s_and_b32 s14, s3, 1
    s_lshl_b32 s14, s14, 3
    s_add_u32 s13, s13, s14
    v_and_b32 v6, 3, v3
    v_lshl_add_u32 v6, v2, 4, v6
    v_add_u32 v6, s13, v6
    v_mul_u32_u24 v6, 896, v6
    v_add_u32 v14, v6, v12
    v_add_u32 v15, v6, v13
    v_add_u32 v15, 3584, v15
    s_lshl_b32 s13, s3, 3
    s_add_u32 s13, s13, s11
    v_add_u32 v6, s13, v3
    v_mul_u32_u24 v6, 896, v6
    s_and_b32 s14, s3, 1
    s_lshl_b32 s14, s14, 6
    v_xor_b32 v7, s14, v12
    v_add_u32 v16, v6, v7
    s_lshl_b32 s74, s3, 11
    s_lshl_b32 s75, s3, 10
    s_add_u32 s75, s75, 49152
    s_lshl_b32 s13, s10, 12
    s_add_u32 s13, s13, 49152
    v_lshrrev_b32 v7, 1, v1
    v_and_b32 v7, 7, v7
    v_xor_b32 v7, v7, v2
    v_lshlrev_b32 v7, 4, v7
    v_lshl_add_u32 v18, v1, 7, v7
    v_add_u32 v18, s13, v18
    v_xor_b32 v19, 32, v18
    v_xor_b32 v20, 64, v18
    v_xor_b32 v21, 0x60, v18
    s_add_u32 m0, s74, 0
    s_mov_b32 s76, 0
    buffer_load_dwordx4 v14, s[44:47], s76 offen lds
    s_add_u32 m0, s74, 1024
    s_mov_b32 s76, 0
    buffer_load_dwordx4 v15, s[44:47], s76 offen lds
    s_add_u32 m0, s75, 0
    s_mov_b32 s76, 0
    buffer_load_dwordx4 v16, s[48:51], s76 offen lds
    s_add_u32 m0, s75, 8192
    s_mov_b32 s76, 0
    buffer_load_dwordx4 v16, s[52:55], s76 offen lds
    s_add_u32 m0, s74, 16384
    s_mov_b32 s76, 128
    buffer_load_dwordx4 v14, s[44:47], s76 offen lds
    s_add_u32 m0, s74, 17408
    s_mov_b32 s76, 128
    buffer_load_dwordx4 v15, s[44:47], s76 offen lds
    s_add_u32 m0, s75, 16384
    s_mov_b32 s76, 128
    buffer_load_dwordx4 v16, s[48:51], s76 offen lds
    s_add_u32 m0, s75, 24576
    s_mov_b32 s76, 128
    buffer_load_dwordx4 v16, s[52:55], s76 offen lds
    s_lshl_b32 s80, s7, 4
    s_add_u32 s80, s80, s6
    s_cmp_ge_u32 s3, 4
    s_cbranch_scc1 pfh4
    s_mul_i32 s81, s80, 128
    s_mov_b32 s82, s3
    s_mul_i32 s82, s82, 32
    s_add_u32 s81, s81, s82
    v_add_u32 v224, s81, v0
    v_lshlrev_b32 v224, 7, v224
    v_cmp_gt_u32 vcc, 32, v0
    v_mov_b32 v225, 0x7fffff00
    s_nop 0
    v_cndmask_b32 v224, v225, v224, vcc
    buffer_load_dword v224, v224, s[44:47], 0 offen
    s_branch pfe4
pfh4:
    s_mul_i32 s81, s80, 28
    s_bfe_u32 s82, s3, 0x10001
    s_mul_i32 s82, s82, 14
    s_add_u32 s81, s81, s82
    v_add_u32 v224, s81, v0
    v_lshlrev_b32 v224, 7, v224
    v_cmp_gt_u32 vcc, 14, v0
    v_mov_b32 v225, 0x7fffff00
    s_nop 0
    v_cndmask_b32 v224, v225, v224, vcc
    s_bitcmp1_b32 s3, 0
    s_cselect_b32 s84, s52, s48
    s_cselect_b32 s85, s53, s49
    s_mov_b32 s86, s50
    s_mov_b32 s87, s51
    buffer_load_dword v224, v224, s[84:87], 0 offen
pfe4:
    s_waitcnt vmcnt(5) lgkmcnt(0)
    s_barrier
    ds_read_b128 v[128:131], v8 offset:0
    ds_read_b128 v[132:135], v18 offset:0
    ds_read_b128 v[136:139], v18 offset:8192
    s_add_u32 m0, s74, 32768
    s_mov_b32 s76, 256
    buffer_load_dwordx4 v14, s[44:47], s76 offen lds
    ds_read_b128 v[140:143], v9 offset:0
    ds_read_b128 v[144:147], v19 offset:0
    ds_read_b128 v[148:151], v19 offset:8192
    s_add_u32 m0, s74, 33792
    s_mov_b32 s76, 256
    buffer_load_dwordx4 v15, s[44:47], s76 offen lds
    ds_read_b128 v[152:155], v10 offset:0
    ds_read_b128 v[156:159], v20 offset:0
    ds_read_b128 v[160:163], v20 offset:8192
    s_add_u32 m0, s75, 32768
    s_mov_b32 s76, 256
    buffer_load_dwordx4 v16, s[48:51], s76 offen lds
    ds_read_b128 v[164:167], v11 offset:0
    ds_read_b128 v[168:171], v21 offset:0
    ds_read_b128 v[172:175], v21 offset:8192
    s_add_u32 m0, s75, 40960
    s_mov_b32 s76, 256
    buffer_load_dwordx4 v16, s[52:55], s76 offen lds
    s_waitcnt vmcnt(5) lgkmcnt(0)
    s_barrier
    ds_read_b128 v[176:179], v8 offset:16384
    ds_read_b128 v[180:183], v18 offset:16384
    ds_read_b128 v[184:187], v18 offset:24576
    v_mfma_f32_32x32x16_bf16 v[32:47], v[128:131], v[132:135], 0
    v_mfma_f32_32x32x16_bf16 v[48:63], v[128:131], v[136:139], 0
    s_add_u32 m0, s74, 0
    s_mov_b32 s76, 384
    buffer_load_dwordx4 v14, s[44:47], s76 offen lds
    ds_read_b128 v[188:191], v9 offset:16384
    ds_read_b128 v[192:195], v19 offset:16384
    ds_read_b128 v[196:199], v19 offset:24576
    v_mfma_f32_32x32x16_bf16 v[32:47], v[140:143], v[144:147], v[32:47]
    v_mfma_f32_32x32x16_bf16 v[48:63], v[140:143], v[148:151], v[48:63]
    s_add_u32 m0, s74, 1024
    s_mov_b32 s76, 384
    buffer_load_dwordx4 v15, s[44:47], s76 offen lds
    ds_read_b128 v[200:203], v10 offset:16384
    ds_read_b128 v[204:207], v20 offset:16384
    ds_read_b128 v[208:211], v20 offset:24576
    v_mfma_f32_32x32x16_bf16 v[32:47], v[152:155], v[156:159], v[32:47]
    v_mfma_f32_32x32x16_bf16 v[48:63], v[152:155], v[160:163], v[48:63]
    s_add_u32 m0, s75, 0
    s_mov_b32 s76, 384
    buffer_load_dwordx4 v16, s[48:51], s76 offen lds
    ds_read_b128 v[212:215], v11 offset:16384
    ds_read_b128 v[216:219], v21 offset:16384
    ds_read_b128 v[220:223], v21 offset:24576
    v_mfma_f32_32x32x16_bf16 v[32:47], v[164:167], v[168:171], v[32:47]
    v_mfma_f32_32x32x16_bf16 v[48:63], v[164:167], v[172:175], v[48:63]
    s_add_u32 m0, s75, 8192
    s_mov_b32 s76, 384
    buffer_load_dwordx4 v16, s[52:55], s76 offen lds
    s_waitcnt vmcnt(4) lgkmcnt(0)
    s_barrier
    ds_read_b128 v[128:131], v8 offset:32768
    ds_read_b128 v[132:135], v18 offset:32768
    ds_read_b128 v[136:139], v18 offset:40960
    v_mfma_f32_32x32x16_bf16 v[32:47], v[176:179], v[180:183], v[32:47]
    v_mfma_f32_32x32x16_bf16 v[48:63], v[176:179], v[184:187], v[48:63]
    s_add_u32 m0, s74, 16384
    s_mov_b32 s76, 512
    buffer_load_dwordx4 v14, s[44:47], s76 offen lds
    ds_read_b128 v[140:143], v9 offset:32768
    ds_read_b128 v[144:147], v19 offset:32768
    ds_read_b128 v[148:151], v19 offset:40960
    v_mfma_f32_32x32x16_bf16 v[32:47], v[188:191], v[192:195], v[32:47]
    v_mfma_f32_32x32x16_bf16 v[48:63], v[188:191], v[196:199], v[48:63]
    s_add_u32 m0, s74, 17408
    s_mov_b32 s76, 512
    buffer_load_dwordx4 v15, s[44:47], s76 offen lds
    ds_read_b128 v[152:155], v10 offset:32768
    ds_read_b128 v[156:159], v20 offset:32768
    ds_read_b128 v[160:163], v20 offset:40960
    v_mfma_f32_32x32x16_bf16 v[32:47], v[200:203], v[204:207], v[32:47]
    v_mfma_f32_32x32x16_bf16 v[48:63], v[200:203], v[208:211], v[48:63]
    s_add_u32 m0, s75, 16384
    s_mov_b32 s76, 512
    buffer_load_dwordx4 v16, s[48:51], s76 offen lds
    ds_read_b128 v[164:167], v11 offset:32768
    ds_read_b128 v[168:171], v21 offset:32768
    ds_read_b128 v[172:175], v21 offset:40960
    v_mfma_f32_32x32x16_bf16 v[32:47], v[212:215], v[216:219], v[32:47]
    v_mfma_f32_32x32x16_bf16 v[48:63], v[212:215], v[220:223], v[48:63]
    s_add_u32 m0, s75, 24576
    s_mov_b32 s76, 512
    buffer_load_dwordx4 v16, s[52:55], s76 offen lds
    s_waitcnt vmcnt(4) lgkmcnt(0)
    s_barrier
    ds_read_b128 v[176:179], v8 offset:0
    ds_read_b128 v[180:183], v18 offset:0
    ds_read_b128 v[184:187], v18 offset:8192
    v_mfma_f32_32x32x16_bf16 v[32:47], v[128:131], v[132:135], v[32:47]
    v_mfma_f32_32x32x16_bf16 v[48:63], v[128:131], v[136:139], v[48:63]
    s_add_u32 m0, s74, 32768
    s_mov_b32 s76, 640
    buffer_load_dwordx4 v14, s[44:47], s76 offen lds
    ds_read_b128 v[188:191], v9 offset:0
    ds_read_b128 v[192:195], v19 offset:0
    ds_read_b128 v[196:199], v19 offset:8192
    v_mfma_f32_32x32x16_bf16 v[32:47], v[140:143], v[144:147], v[32:47]
    v_mfma_f32_32x32x16_bf16 v[48:63], v[140:143], v[148:151], v[48:63]
    s_add_u32 m0, s74, 33792
    s_mov_b32 s76, 640
    buffer_load_dwordx4 v15, s[44:47], s76 offen lds
    ds_read_b128 v[200:203], v10 offset:0
    ds_read_b128 v[204:207], v20 offset:0
    ds_read_b128 v[208:211], v20 offset:8192
    v_mfma_f32_32x32x16_bf16 v[32:47], v[152:155], v[156:159], v[32:47]
    v_mfma_f32_32x32x16_bf16 v[48:63], v[152:155], v[160:163], v[48:63]
    s_add_u32 m0, s75, 32768
    s_mov_b32 s76, 640
    buffer_load_dwordx4 v16, s[48:51], s76 offen lds
    ds_read_b128 v[212:215], v11 offset:0
    ds_read_b128 v[216:219], v21 offset:0
    ds_read_b128 v[220:223], v21 offset:8192
    v_mfma_f32_32x32x16_bf16 v[32:47], v[164:167], v[168:171], v[32:47]
    v_mfma_f32_32x32x16_bf16 v[48:63], v[164:167], v[172:175], v[48:63]
    s_add_u32 m0, s75, 40960
    s_mov_b32 s76, 640
    buffer_load_dwordx4 v16, s[52:55], s76 offen lds
    s_waitcnt vmcnt(4) lgkmcnt(0)
    s_barrier
    ds_read_b128 v[128:131], v8 offset:16384
    ds_read_b128 v[132:135], v18 offset:16384
    ds_read_b128 v[136:139], v18 offset:24576
    v_mfma_f32_32x32x16_bf16 v[32:47], v[176:179], v[180:183], v[32:47]
    v_mfma_f32_32x32x16_bf16 v[48:63], v[176:179], v[184:187], v[48:63]
    s_add_u32 m0, s74, 0
    s_mov_b32 s76, 768
    buffer_load_dwordx4 v14, s[44:47], s76 offen lds
    ds_read_b128 v[140:143], v9 offset:16384
    ds_read_b128 v[144:147], v19 offset:16384
    ds_read_b128 v[148:151], v19 offset:24576
    v_mfma_f32_32x32x16_bf16 v[32:47], v[188:191], v[192:195], v[32:47]
    v_mfma_f32_32x32x16_bf16 v[48:63], v[188:191], v[196:199], v[48:63]
    s_add_u32 m0, s74, 1024
    s_mov_b32 s76, 768
    buffer_load_dwordx4 v15, s[44:47], s76 offen lds
    ds_read_b128 v[152:155], v10 offset:16384
    ds_read_b128 v[156:159], v20 offset:16384
    ds_read_b128 v[160:163], v20 offset:24576
    v_mfma_f32_32x32x16_bf16 v[32:47], v[200:203], v[204:207], v[32:47]
    v_mfma_f32_32x32x16_bf16 v[48:63], v[200:203], v[208:211], v[48:63]
    s_add_u32 m0, s75, 0
    s_mov_b32 s76, 768
    buffer_load_dwordx4 v16, s[48:51], s76 offen lds
    ds_read_b128 v[164:167], v11 offset:16384
    ds_read_b128 v[168:171], v21 offset:16384
    ds_read_b128 v[172:175], v21 offset:24576
    v_mfma_f32_32x32x16_bf16 v[32:47], v[212:215], v[216:219], v[32:47]
    v_mfma_f32_32x32x16_bf16 v[48:63], v[212:215], v[220:223], v[48:63]
    s_add_u32 m0, s75, 8192
    s_mov_b32 s76, 768
    buffer_load_dwordx4 v16, s[52:55], s76 offen lds
    s_waitcnt vmcnt(4) lgkmcnt(0)
    s_barrier
    ds_read_b128 v[176:179], v8 offset:32768
    ds_read_b128 v[180:183], v18 offset:32768
    ds_read_b128 v[184:187], v18 offset:40960
    v_mfma_f32_32x32x16_bf16 v[32:47], v[128:131], v[132:135], v[32:47]
    v_mfma_f32_32x32x16_bf16 v[48:63], v[128:131], v[136:139], v[48:63]
    ds_read_b128 v[188:191], v9 offset:32768
    ds_read_b128 v[192:195], v19 offset:32768
    ds_read_b128 v[196:199], v19 offset:40960
    v_mfma_f32_32x32x16_bf16 v[32:47], v[140:143], v[144:147], v[32:47]
    v_mfma_f32_32x32x16_bf16 v[48:63], v[140:143], v[148:151], v[48:63]
    ds_read_b128 v[200:203], v10 offset:32768
    ds_read_b128 v[204:207], v20 offset:32768
    ds_read_b128 v[208:211], v20 offset:40960
    v_mfma_f32_32x32x16_bf16 v[32:47], v[152:155], v[156:159], v[32:47]
    v_mfma_f32_32x32x16_bf16 v[48:63], v[152:155], v[160:163], v[48:63]
    ds_read_b128 v[212:215], v11 offset:32768
    ds_read_b128 v[216:219], v21 offset:32768
    ds_read_b128 v[220:223], v21 offset:40960
    v_mfma_f32_32x32x16_bf16 v[32:47], v[164:167], v[168:171], v[32:47]
    v_mfma_f32_32x32x16_bf16 v[48:63], v[164:167], v[172:175], v[48:63]
    s_waitcnt vmcnt(0) lgkmcnt(0)
    s_barrier
    ds_read_b128 v[128:131], v8 offset:0
    ds_read_b128 v[132:135], v18 offset:0
    ds_read_b128 v[136:139], v18 offset:8192
    v_mfma_f32_32x32x16_bf16 v[32:47], v[176:179], v[180:183], v[32:47]
    v_mfma_f32_32x32x16_bf16 v[48:63], v[176:179], v[184:187], v[48:63]
    ds_read_b128 v[140:143], v9 offset:0
    ds_read_b128 v[144:147], v19 offset:0
    ds_read_b128 v[148:151], v19 offset:8192
    v_mfma_f32_32x32x16_bf16 v[32:47], v[188:191], v[192:195], v[32:47]
    v_mfma_f32_32x32x16_bf16 v[48:63], v[188:191], v[196:199], v[48:63]
    ds_read_b128 v[152:155], v10 offset:0
    ds_read_b128 v[156:159], v20 offset:0
    ds_read_b128 v[160:163], v20 offset:8192
    v_mfma_f32_32x32x16_bf16 v[32:47], v[200:203], v[204:207], v[32:47]
    v_mfma_f32_32x32x16_bf16 v[48:63], v[200:203], v[208:211], v[48:63]
    ds_read_b128 v[164:167], v11 offset:0
    ds_read_b128 v[168:171], v21 offset:0
    ds_read_b128 v[172:175], v21 offset:8192
    v_mfma_f32_32x32x16_bf16 v[32:47], v[212:215], v[216:219], v[32:47]
    v_mfma_f32_32x32x16_bf16 v[48:63], v[212:215], v[220:223], v[48:63]
    s_waitcnt lgkmcnt(0)
    v_mfma_f32_32x32x16_bf16 v[32:47], v[128:131], v[132:135], v[32:47]
    v_mfma_f32_32x32x16_bf16 v[48:63], v[128:131], v[136:139], v[48:63]
    v_mfma_f32_32x32x16_bf16 v[32:47], v[140:143], v[144:147], v[32:47]
    v_mfma_f32_32x32x16_bf16 v[48:63], v[140:143], v[148:151], v[48:63]
    v_mfma_f32_32x32x16_bf16 v[32:47], v[152:155], v[156:159], v[32:47]
    v_mfma_f32_32x32x16_bf16 v[48:63], v[152:155], v[160:163], v[48:63]
    v_mfma_f32_32x32x16_bf16 v[32:47], v[164:167], v[168:171], v[32:47]
    v_mfma_f32_32x32x16_bf16 v[48:63], v[164:167], v[172:175], v[48:63]
    v_lshlrev_b32 v116, 16, v116
    v_lshlrev_b32 v117, 16, v117
    v_lshlrev_b32 v118, 16, v118
    v_mul_f32 v118, 0x3fb8aa3b, v118
    v_exp_f32 v118, v118
    s_nop 0
    v_cvt_pk_bf16_f32 v118, v118, v118
    v_lshlrev_b32 v118, 16, v118
    v_mul_f32 v119, v118, v116
    v_mul_f32 v120, v118, v117
    v_mul_f32 v119, 0x3fb8aa3b, v119
    v_mul_f32 v120, 0.15915494, v120
    v_exp_f32 v119, v119
    v_fract_f32 v120, v120
    v_cos_f32 v112, v120
    v_sin_f32 v113, v120
    s_nop 0
    v_mul_f32 v112, v112, v119
    v_mul_f32 v113, v113, v119
    v_add_f32 v119, -1.0, v112
    v_mul_f32 v120, v116, v116
    v_fmac_f32 v120, v117, v117
    v_rcp_f32 v120, v120
    v_mul_f32 v114, v119, v116
    v_fmac_f32 v114, v113, v117
    v_mul_f32 v115, v113, v116
    v_fma_f32 v115, -v119, v117, v115
    v_mul_f32 v114, v114, v120
    v_mul_f32 v115, v115, v120
    s_nop 7
    s_lshl_b32 s13, s6, 7
    s_lshl_b32 s14, s9, 5
    s_add_u32 s13, s13, s14
    v_lshl_add_u32 v6, v2, 4, s13
    v_mul_u32_u24 v6, 448, v6
    v_add_u32 v6, v6, v25
    v_lshlrev_b32 v6, 2, v6
    v_mul_f32 v117, v115, v48
    v_fma_f32 v80, v114, v32, -v117
    v_mul_f32 v117, v115, v32
    v_fma_f32 v81, v114, v48, v117
    v_cvt_pk_bf16_f32 v128, v80, v81
    s_mov_b32 s76, 0
    buffer_store_dword v128, v6, s[56:59], s76 offen
    v_fma_f32 v116, -v113, v48, v33
    v_fma_f32 v49, v112, v48, v49
    v_fma_f32 v49, v113, v32, v49
    v_fma_f32 v33, v112, v32, v116
    v_mul_f32 v117, v115, v49
    v_fma_f32 v82, v114, v33, -v117
    v_mul_f32 v117, v115, v33
    v_fma_f32 v83, v114, v49, v117
    v_cvt_pk_bf16_f32 v129, v82, v83
    s_mov_b32 s76, 1792
    buffer_store_dword v129, v6, s[56:59], s76 offen
    v_fma_f32 v116, -v113, v49, v34
    v_fma_f32 v50, v112, v49, v50
    v_fma_f32 v50, v113, v33, v50
    v_fma_f32 v34, v112, v33, v116
    v_mul_f32 v117, v115, v50
    v_fma_f32 v84, v114, v34, -v117
    v_mul_f32 v117, v115, v34
    v_fma_f32 v85, v114, v50, v117
    v_cvt_pk_bf16_f32 v130, v84, v85
    s_mov_b32 s76, 3584
    buffer_store_dword v130, v6, s[56:59], s76 offen
    v_fma_f32 v116, -v113, v50, v35
    v_fma_f32 v51, v112, v50, v51
    v_fma_f32 v51, v113, v34, v51
    v_fma_f32 v35, v112, v34, v116
    v_mul_f32 v117, v115, v51
    v_fma_f32 v86, v114, v35, -v117
    v_mul_f32 v117, v115, v35
    v_fma_f32 v87, v114, v51, v117
    v_cvt_pk_bf16_f32 v131, v86, v87
    s_mov_b32 s76, 5376
    buffer_store_dword v131, v6, s[56:59], s76 offen
    v_fma_f32 v116, -v113, v51, v36
    v_fma_f32 v52, v112, v51, v52
    v_fma_f32 v52, v113, v35, v52
    v_fma_f32 v36, v112, v35, v116
    v_mul_f32 v117, v115, v52
    v_fma_f32 v88, v114, v36, -v117
    v_mul_f32 v117, v115, v36
    v_fma_f32 v89, v114, v52, v117
    v_cvt_pk_bf16_f32 v132, v88, v89
    s_mov_b32 s76, 7168
    buffer_store_dword v132, v6, s[56:59], s76 offen
    v_fma_f32 v116, -v113, v52, v37
    v_fma_f32 v53, v112, v52, v53
    v_fma_f32 v53, v113, v36, v53
    v_fma_f32 v37, v112, v36, v116
    v_mul_f32 v117, v115, v53
    v_fma_f32 v90, v114, v37, -v117
    v_mul_f32 v117, v115, v37
    v_fma_f32 v91, v114, v53, v117
    v_cvt_pk_bf16_f32 v133, v90, v91
    s_mov_b32 s76, 8960
    buffer_store_dword v133, v6, s[56:59], s76 offen
    v_fma_f32 v116, -v113, v53, v38
    v_fma_f32 v54, v112, v53, v54
    v_fma_f32 v54, v113, v37, v54
    v_fma_f32 v38, v112, v37, v116
    v_mul_f32 v117, v115, v54
    v_fma_f32 v92, v114, v38, -v117
    v_mul_f32 v117, v115, v38
    v_fma_f32 v93, v114, v54, v117
    v_cvt_pk_bf16_f32 v134, v92, v93
    s_mov_b32 s76, 10752
    buffer_store_dword v134, v6, s[56:59], s76 offen
    v_fma_f32 v116, -v113, v54, v39
    v_fma_f32 v55, v112, v54, v55
    v_fma_f32 v55, v113, v38, v55
    v_fma_f32 v39, v112, v38, v116
    v_mul_f32 v117, v115, v55
    v_fma_f32 v94, v114, v39, -v117
    v_mul_f32 v117, v115, v39
    v_fma_f32 v95, v114, v55, v117
    v_cvt_pk_bf16_f32 v135, v94, v95
    s_mov_b32 s76, 12544
    buffer_store_dword v135, v6, s[56:59], s76 offen
    v_fma_f32 v116, -v113, v55, v40
    v_fma_f32 v56, v112, v55, v56
    v_fma_f32 v56, v113, v39, v56
    v_fma_f32 v40, v112, v39, v116
    v_mul_f32 v117, v115, v56
    v_fma_f32 v96, v114, v40, -v117
    v_mul_f32 v117, v115, v40
    v_fma_f32 v97, v114, v56, v117
    v_cvt_pk_bf16_f32 v136, v96, v97
    s_mov_b32 s76, 14336
    buffer_store_dword v136, v6, s[56:59], s76 offen
    v_fma_f32 v116, -v113, v56, v41
    v_fma_f32 v57, v112, v56, v57
    v_fma_f32 v57, v113, v40, v57
    v_fma_f32 v41, v112, v40, v116
    v_mul_f32 v117, v115, v57
    v_fma_f32 v98, v114, v41, -v117
    v_mul_f32 v117, v115, v41
    v_fma_f32 v99, v114, v57, v117
    v_cvt_pk_bf16_f32 v137, v98, v99
    s_mov_b32 s76, 16128
    buffer_store_dword v137, v6, s[56:59], s76 offen
    v_fma_f32 v116, -v113, v57, v42
    v_fma_f32 v58, v112, v57, v58
    v_fma_f32 v58, v113, v41, v58
    v_fma_f32 v42, v112, v41, v116
    v_mul_f32 v117, v115, v58
    v_fma_f32 v100, v114, v42, -v117
    v_mul_f32 v117, v115, v42
    v_fma_f32 v101, v114, v58, v117
    v_cvt_pk_bf16_f32 v138, v100, v101
    s_mov_b32 s76, 17920
    buffer_store_dword v138, v6, s[56:59], s76 offen
    v_fma_f32 v116, -v113, v58, v43
    v_fma_f32 v59, v112, v58, v59
    v_fma_f32 v59, v113, v42, v59
    v_fma_f32 v43, v112, v42, v116
    v_mul_f32 v117, v115, v59
    v_fma_f32 v102, v114, v43, -v117
    v_mul_f32 v117, v115, v43
    v_fma_f32 v103, v114, v59, v117
    v_cvt_pk_bf16_f32 v139, v102, v103
    s_mov_b32 s76, 19712
    buffer_store_dword v139, v6, s[56:59], s76 offen
    v_fma_f32 v116, -v113, v59, v44
    v_fma_f32 v60, v112, v59, v60
    v_fma_f32 v60, v113, v43, v60
    v_fma_f32 v44, v112, v43, v116
    v_mul_f32 v117, v115, v60
    v_fma_f32 v104, v114, v44, -v117
    v_mul_f32 v117, v115, v44
    v_fma_f32 v105, v114, v60, v117
    v_cvt_pk_bf16_f32 v140, v104, v105
    s_mov_b32 s76, 21504
    buffer_store_dword v140, v6, s[56:59], s76 offen
    v_fma_f32 v116, -v113, v60, v45
    v_fma_f32 v61, v112, v60, v61
    v_fma_f32 v61, v113, v44, v61
    v_fma_f32 v45, v112, v44, v116
    v_mul_f32 v117, v115, v61
    v_fma_f32 v106, v114, v45, -v117
    v_mul_f32 v117, v115, v45
    v_fma_f32 v107, v114, v61, v117
    v_cvt_pk_bf16_f32 v141, v106, v107
    s_mov_b32 s76, 23296
    buffer_store_dword v141, v6, s[56:59], s76 offen
    v_fma_f32 v116, -v113, v61, v46
    v_fma_f32 v62, v112, v61, v62
    v_fma_f32 v62, v113, v45, v62
    v_fma_f32 v46, v112, v45, v116
    v_mul_f32 v117, v115, v62
    v_fma_f32 v108, v114, v46, -v117
    v_mul_f32 v117, v115, v46
    v_fma_f32 v109, v114, v62, v117
    v_cvt_pk_bf16_f32 v142, v108, v109
    s_mov_b32 s76, 25088
    buffer_store_dword v142, v6, s[56:59], s76 offen
    v_fma_f32 v116, -v113, v62, v47
    v_fma_f32 v63, v112, v62, v63
    v_fma_f32 v63, v113, v46, v63
    v_fma_f32 v47, v112, v46, v116
    v_mul_f32 v117, v115, v63
    v_fma_f32 v110, v114, v47, -v117
    v_mul_f32 v117, v115, v47
    v_fma_f32 v111, v114, v63, v117
    v_cvt_pk_bf16_f32 v143, v110, v111
    s_mov_b32 s76, 26880
    buffer_store_dword v143, v6, s[56:59], s76 offen
    v_mul_f32 v120, v113, v113
    v_fma_f32 v116, v112, v112, -v120
    v_mul_f32 v117, v112, v113
    v_add_f32 v117, v117, v117
    v_mul_f32 v120, v117, v117
    v_fma_f32 v118, v116, v116, -v120
    v_mul_f32 v119, v116, v117
    v_add_f32 v119, v119, v119
    v_mul_f32 v120, v119, v119
    v_fma_f32 v116, v118, v118, -v120
    v_mul_f32 v117, v118, v119
    v_add_f32 v117, v117, v117
    v_mul_f32 v120, v117, v117
    v_fma_f32 v118, v116, v116, -v120
    v_mul_f32 v119, v116, v117
    v_add_f32 v119, v119, v119
    s_barrier
    s_lshl_b32 s13, s9, 7
    s_lshl_b32 s14, s10, 5
    s_add_u32 s13, s13, s14
    v_lshl_add_u32 v7, v2, 6, s13
    v_add_u32 v7, v7, v1
    v_lshlrev_b32 v7, 3, v7
    ds_write_b64 v7, v[110:111]
    v_add_u32 v7, s14, v1
    v_lshlrev_b32 v7, 3, v7
    ds_write_b64 v7, v[118:119] offset:4096
    s_waitcnt lgkmcnt(0)
    s_barrier
    s_cmp_lg_u32 s3, 0
    s_cbranch_scc1 k1_exit
    s_add_u32 s60, s42, 0xd00000
    s_addc_u32 s61, s43, 0
    s_mov_b32 s62, 0x70000
    s_mov_b32 s63, 0x20000
    s_add_u32 s64, s42, 0xd80000
    s_addc_u32 s65, s43, 0
    s_mov_b32 s66, 0xe000
    s_mov_b32 s67, 0x20000
    v_lshlrev_b32 v7, 3, v0
    ds_read_b64 v[32:33], v7 offset:0
    ds_read_b64 v[34:35], v7 offset:512
    ds_read_b64 v[36:37], v7 offset:1024
    ds_read_b64 v[38:39], v7 offset:1536
    ds_read_b64 v[40:41], v7 offset:2048
    ds_read_b64 v[42:43], v7 offset:2560
    ds_read_b64 v[44:45], v7 offset:3072
    ds_read_b64 v[46:47], v7 offset:3584
    ds_read_b64 v[48:49], v7 offset:4096
    s_mul_i32 s13, s6, 8*3584
    s_lshl_b32 s14, s7, 9
    s_add_u32 s13, s13, s14
    s_mul_i32 s15, s6, 3584
    s_add_u32 s15, s15, s14
    v_mov_b32 v50, 0
    v_mov_b32 v51, 0
    s_waitcnt lgkmcnt(0)
    buffer_store_dwordx2 v[50:51], v7, s[60:63], s13 offen
    s_add_u32 s13, s13, 3584
    v_fma_f32 v70, -v49, v51, v32
    v_fma_f32 v53, v48, v51, v33
    v_fma_f32 v53, v49, v50, v53
    v_fma_f32 v52, v48, v50, v70
    buffer_store_dwordx2 v[52:53], v7, s[60:63], s13 offen
    s_add_u32 s13, s13, 3584
    v_fma_f32 v70, -v49, v53, v34
    v_fma_f32 v55, v48, v53, v35
    v_fma_f32 v55, v49, v52, v55
    v_fma_f32 v54, v48, v52, v70
    buffer_store_dwordx2 v[54:55], v7, s[60:63], s13 offen
    s_add_u32 s13, s13, 3584
    v_fma_f32 v70, -v49, v55, v36
    v_fma_f32 v57, v48, v55, v37
    v_fma_f32 v57, v49, v54, v57
    v_fma_f32 v56, v48, v54, v70
    buffer_store_dwordx2 v[56:57], v7, s[60:63], s13 offen
    s_add_u32 s13, s13, 3584
    v_fma_f32 v70, -v49, v57, v38
    v_fma_f32 v59, v48, v57, v39
    v_fma_f32 v59, v49, v56, v59
    v_fma_f32 v58, v48, v56, v70
    buffer_store_dwordx2 v[58:59], v7, s[60:63], s13 offen
    s_add_u32 s13, s13, 3584
    v_fma_f32 v70, -v49, v59, v40
    v_fma_f32 v61, v48, v59, v41
    v_fma_f32 v61, v49, v58, v61
    v_fma_f32 v60, v48, v58, v70
    buffer_store_dwordx2 v[60:61], v7, s[60:63], s13 offen
    s_add_u32 s13, s13, 3584
    v_fma_f32 v70, -v49, v61, v42
    v_fma_f32 v63, v48, v61, v43
    v_fma_f32 v63, v49, v60, v63
    v_fma_f32 v62, v48, v60, v70
    buffer_store_dwordx2 v[62:63], v7, s[60:63], s13 offen
    s_add_u32 s13, s13, 3584
    v_fma_f32 v70, -v49, v63, v44
    v_fma_f32 v65, v48, v63, v45
    v_fma_f32 v65, v49, v62, v65
    v_fma_f32 v64, v48, v62, v70
    buffer_store_dwordx2 v[64:65], v7, s[60:63], s13 offen
    s_add_u32 s13, s13, 3584
    v_fma_f32 v70, -v49, v65, v46
    v_fma_f32 v67, v48, v65, v47
    v_fma_f32 v67, v49, v64, v67
    v_fma_f32 v66, v48, v64, v70
    buffer_store_dwordx2 v[66:67], v7, s[64:67], s15 offen
k1_exit:
    s_endpgm
.globl k2_kernel
.p2align 8
.type k2_kernel,@function
k2_kernel:
    s_cmp_ge_u32 s2, 256
    s_cbranch_scc1 k2_exit
    s_load_dwordx16 s[16:31], s[0:1], 0
    s_load_dwordx8 s[32:39], s[0:1], 64
    s_load_dwordx2 s[40:41], s[0:1], 96
    s_load_dwordx2 s[42:43], s[0:1], 112
    v_lshrrev_b32 v1, 6, v0
    v_and_b32 v0, 63, v0
    s_nop 0
    v_readfirstlane_b32 s3, v1
    s_and_b32 s4, s2, 7
    s_lshl_b32 s4, s4, 1
    s_lshr_b32 s5, s2, 3
    s_and_b32 s5, s5, 1
    s_add_u32 s4, s4, s5
    s_lshr_b32 s5, s2, 4
    v_and_b32 v1, 31, v0
    v_lshrrev_b32 v2, 5, v0
    v_lshlrev_b32 v3, 4, v0
    s_waitcnt lgkmcnt(0)
    s_mov_b32 s44, s42
    s_mov_b32 s45, s43
    s_mov_b32 s46, 0x200000
    s_mov_b32 s47, 0x20000
    s_add_u32 s48, s42, 0x200000
    s_addc_u32 s49, s43, 0
    s_mov_b32 s50, 0x400000
    s_mov_b32 s51, 0x20000
    s_add_u32 s56, s42, 0x1200000
    s_addc_u32 s57, s43, 0
    s_mov_b32 s58, 0x1c0000
    s_mov_b32 s59, 0x20000
    s_lshl_b32 s11, s4, 6
    s_lshl_b32 s12, s5, 2
    s_add_u32 s12, s12, s11
    s_lshl_b32 s12, s12, 11
    s_lshl_b32 s8, s3, 10
    s_add_u32 s12, s12, s8
    s_add_u32 m0, s8, 131328
    s_lshl_b32 s14, s11, 11
    buffer_load_dwordx4 v3, s[44:47], s12 offen lds
    s_cmp_ge_u32 s3, 2
    s_cbranch_scc1 k2_nok0
    s_add_u32 m0, s8, 139520
    s_add_u32 s12, s14, s8
    buffer_load_dwordx4 v3, s[48:51], s12 offen lds
k2_nok0:
    s_lshl_b32 s13, s3, 3
    s_add_u32 s13, s13, s11
    s_lshl_b32 s13, s13, 11
    s_mov_b32 s90, s13
    v_add_u32 v8, 131328, v3
    s_cmp_ge_u32 s3, 4
    s_cbranch_scc1 k2_e1
    s_add_u32 s15, s90, 0x200000
    buffer_load_dwordx4 v[16:19], v3, s[48:51], s90 offen
    buffer_load_dwordx4 v[20:23], v3, s[48:51], s90 offen offset:1024
    buffer_load_dwordx4 v[24:27], v3, s[48:51], s15 offen
    buffer_load_dwordx4 v[28:31], v3, s[48:51], s15 offen offset:1024
    s_add_u32 s90, s90, 2048
    s_waitcnt vmcnt(4)
    s_branch k2_e2
k2_e1:
    s_waitcnt vmcnt(0)
k2_e2:
    s_barrier
    ds_read_b128 v[144:147], v8 offset:0
    ds_read_b128 v[148:151], v8 offset:1024
    ds_read_b128 v[152:155], v8 offset:2048
    ds_read_b128 v[156:159], v8 offset:3072
    ds_read_b128 v[160:163], v8 offset:4096
    ds_read_b128 v[164:167], v8 offset:5120
    ds_read_b128 v[168:171], v8 offset:6144
    ds_read_b128 v[172:175], v8 offset:7168
    s_mov_b32 s60, s18
    s_mov_b32 s61, s19
    s_mov_b32 s62, 0x380
    s_mov_b32 s63, 0x20000
    s_mov_b32 s64, s20
    s_mov_b32 s65, s21
    s_mov_b32 s66, 0x380
    s_mov_b32 s67, 0x20000
    s_mov_b32 s68, s30
    s_mov_b32 s69, s31
    s_mov_b32 s70, 0x380
    s_mov_b32 s71, 0x20000
    s_add_u32 s72, s42, 0x600000
    s_addc_u32 s73, s43, 0
    s_mov_b32 s74, 0x380000
    s_mov_b32 s75, 0x20000
    s_add_u32 s76, s42, 0xd00000
    s_addc_u32 s77, s43, 0
    s_mov_b32 s78, 0x70000
    s_mov_b32 s79, 0x20000
    s_add_u32 s80, s42, 0xd80000
    s_addc_u32 s81, s43, 0
    s_mov_b32 s82, 0xe000
    s_mov_b32 s83, 0x20000
    s_add_u32 s84, s42, 0xe00000
    s_addc_u32 s85, s43, 0
    s_mov_b32 s86, 0x380000
    s_mov_b32 s87, 0x20000
    s_lshr_b32 s6, s2, 1
    s_and_b32 s7, s2, 1
    s_mul_i32 s7, s7, 224
    s_lshl_b32 s8, s3, 6
    v_add_u32 v9, s8, v0
    v_cmp_gt_u32 vcc, 224, v9
    v_add_u32 v9, s7, v9
    v_mov_b32 v10, 0x0fffffff
    v_lshlrev_b32 v250, 1, v9
    v_cndmask_b32 v9, v10, v9, vcc
    v_lshlrev_b32 v250, 1, v9
    v_lshlrev_b32 v251, 2, v9
    v_lshlrev_b32 v10, 3, v9
    s_lshr_b32 s9, s6, 3
    s_mov_b32 s10, 0
    s_cmp_ge_u32 s3, 4
    s_cbranch_scc1 k2_noside1
    buffer_load_ushort v116, v250, s[60:63], 0 offen
    buffer_load_ushort v117, v250, s[64:67], 0 offen
    buffer_load_ushort v118, v250, s[68:71], 0 offen
    s_mul_i32 s8, s6, 3584
    buffer_load_dwordx2 v[242:243], v10, s[76:79], s8 offen
    s_cmp_le_u32 s9, 0
    s_cbranch_scc1 k2_noside1
    buffer_load_dwordx2 v[80:81], v10, s[80:83], s10 offen
    s_add_u32 s10, s10, 3584
    s_cmp_le_u32 s9, 1
    s_cbranch_scc1 k2_noside1
    buffer_load_dwordx2 v[82:83], v10, s[80:83], s10 offen
    s_add_u32 s10, s10, 3584
    s_cmp_le_u32 s9, 2
    s_cbranch_scc1 k2_noside1
    buffer_load_dwordx2 v[84:85], v10, s[80:83], s10 offen
    s_add_u32 s10, s10, 3584
    s_cmp_le_u32 s9, 3
    s_cbranch_scc1 k2_noside1
    buffer_load_dwordx2 v[86:87], v10, s[80:83], s10 offen
    s_add_u32 s10, s10, 3584
    s_cmp_le_u32 s9, 4
    s_cbranch_scc1 k2_noside1
    buffer_load_dwordx2 v[88:89], v10, s[80:83], s10 offen
    s_add_u32 s10, s10, 3584
    s_cmp_le_u32 s9, 5
    s_cbranch_scc1 k2_noside1
    buffer_load_dwordx2 v[90:91], v10, s[80:83], s10 offen
    s_add_u32 s10, s10, 3584
    s_cmp_le_u32 s9, 6
    s_cbranch_scc1 k2_noside1
    buffer_load_dwordx2 v[92:93], v10, s[80:83], s10 offen
    s_add_u32 s10, s10, 3584
    s_cmp_le_u32 s9, 7
    s_cbranch_scc1 k2_noside1
    buffer_load_dwordx2 v[94:95], v10, s[80:83], s10 offen
    s_add_u32 s10, s10, 3584
    s_cmp_le_u32 s9, 8
    s_cbranch_scc1 k2_noside1
    buffer_load_dwordx2 v[96:97], v10, s[80:83], s10 offen
    s_add_u32 s10, s10, 3584
    s_cmp_le_u32 s9, 9
    s_cbranch_scc1 k2_noside1
    buffer_load_dwordx2 v[98:99], v10, s[80:83], s10 offen
    s_add_u32 s10, s10, 3584
    s_cmp_le_u32 s9, 10
    s_cbranch_scc1 k2_noside1
    buffer_load_dwordx2 v[100:101], v10, s[80:83], s10 offen
    s_add_u32 s10, s10, 3584
    s_cmp_le_u32 s9, 11
    s_cbranch_scc1 k2_noside1
    buffer_load_dwordx2 v[102:103], v10, s[80:83], s10 offen
    s_add_u32 s10, s10, 3584
    s_cmp_le_u32 s9, 12
    s_cbranch_scc1 k2_noside1
    buffer_load_dwordx2 v[104:105], v10, s[80:83], s10 offen
    s_add_u32 s10, s10, 3584
    s_cmp_le_u32 s9, 13
    s_cbranch_scc1 k2_noside1
    buffer_load_dwordx2 v[106:107], v10, s[80:83], s10 offen
    s_add_u32 s10, s10, 3584
    s_cmp_le_u32 s9, 14
    s_cbranch_scc1 k2_noside1
    buffer_load_dwordx2 v[108:109], v10, s[80:83], s10 offen
    s_add_u32 s10, s10, 3584
k2_noside1:
    s_cmp_lt_u32 s3, 4
    s_cbranch_scc1 k2_e3
    s_add_u32 s15, s90, 0x200000
    buffer_load_dwordx4 v[16:19], v3, s[48:51], s90 offen
    buffer_load_dwordx4 v[20:23], v3, s[48:51], s90 offen offset:1024
    buffer_load_dwordx4 v[24:27], v3, s[48:51], s15 offen
    buffer_load_dwordx4 v[28:31], v3, s[48:51], s15 offen offset:1024
    s_add_u32 s90, s90, 2048
k2_e3:
    s_add_u32 s15, s90, 0x200000
    buffer_load_dwordx4 v[32:35], v3, s[48:51], s90 offen
    buffer_load_dwordx4 v[36:39], v3, s[48:51], s90 offen offset:1024
    buffer_load_dwordx4 v[40:43], v3, s[48:51], s15 offen
    buffer_load_dwordx4 v[44:47], v3, s[48:51], s15 offen offset:1024
    s_add_u32 s90, s90, 2048
    v_cmp_le_u32 s[88:89], 32, v0
    s_mov_b32 s91, 1
    s_mov_b32 s95, 0
k2_restart:
    v_add_u32 v8, 139520, v3
    ds_read_b128 v[208:211], v8
    ds_read_b128 v[212:215], v8 offset:1024
    s_waitcnt lgkmcnt(0)
    v_cndmask_b32 v150, v150, 0, s[88:89]
    v_mov_b32 v4, 0xff800000
    v_cndmask_b32 v158, v158, 0, s[88:89]
    v_mov_b32 v5, 0xff800000
    v_cndmask_b32 v166, v166, 0, s[88:89]
    v_mov_b32 v6, 0xff800000
    v_cndmask_b32 v174, v174, 0, s[88:89]
    v_mov_b32 v7, 0xff800000
    s_mov_b32 s92, s14
    s_mov_b32 s93, s91
k2_maxloop:
    v_mfma_f32_32x32x16_bf16 v[176:191], v[208:211], v[144:147], 0
    v_mfma_f32_32x32x16_bf16 v[176:191], v[212:215], v[148:151], v[176:191]
    v_mfma_f32_32x32x16_bf16 v[192:207], v[208:211], v[152:155], 0
    v_mfma_f32_32x32x16_bf16 v[192:207], v[212:215], v[156:159], v[192:207]
    s_nop 15
    v_max3_f32 v4, v176, v177, v4
    v_max3_f32 v4, v178, v179, v4
    v_max3_f32 v4, v180, v181, v4
    v_max3_f32 v4, v182, v183, v4
    v_max3_f32 v4, v184, v185, v4
    v_max3_f32 v4, v186, v187, v4
    v_max3_f32 v4, v188, v189, v4
    v_max3_f32 v4, v190, v191, v4
    v_max3_f32 v5, v192, v193, v5
    v_max3_f32 v5, v194, v195, v5
    v_max3_f32 v5, v196, v197, v5
    v_max3_f32 v5, v198, v199, v5
    v_max3_f32 v5, v200, v201, v5
    v_max3_f32 v5, v202, v203, v5
    v_max3_f32 v5, v204, v205, v5
    v_max3_f32 v5, v206, v207, v5
    s_nop 7
    v_mfma_f32_32x32x16_bf16 v[176:191], v[208:211], v[160:163], 0
    v_mfma_f32_32x32x16_bf16 v[176:191], v[212:215], v[164:167], v[176:191]
    v_mfma_f32_32x32x16_bf16 v[192:207], v[208:211], v[168:171], 0
    v_mfma_f32_32x32x16_bf16 v[192:207], v[212:215], v[172:175], v[192:207]
    s_nop 15
    v_max3_f32 v6, v176, v177, v6
    v_max3_f32 v6, v178, v179, v6
    v_max3_f32 v6, v180, v181, v6
    v_max3_f32 v6, v182, v183, v6
    v_max3_f32 v6, v184, v185, v6
    v_max3_f32 v6, v186, v187, v6
    v_max3_f32 v6, v188, v189, v6
    v_max3_f32 v6, v190, v191, v6
    v_max3_f32 v7, v192, v193, v7
    v_max3_f32 v7, v194, v195, v7
    v_max3_f32 v7, v196, v197, v7
    v_max3_f32 v7, v198, v199, v7
    v_max3_f32 v7, v200, v201, v7
    v_max3_f32 v7, v202, v203, v7
    v_max3_f32 v7, v204, v205, v7
    v_max3_f32 v7, v206, v207, v7
    s_nop 7
    s_sub_u32 s93, s93, 1
    s_cmp_eq_u32 s93, 0
    s_cbranch_scc1 k2_maxdone
    s_add_u32 s92, s92, 2048
    buffer_load_dwordx4 v[208:211], v3, s[48:51], s92 offen
    buffer_load_dwordx4 v[212:215], v3, s[48:51], s92 offen offset:1024
    s_waitcnt vmcnt(0)
    s_branch k2_maxloop
k2_maxdone:
    v_mov_b32 v8, v4
    s_nop 1
    v_permlane32_swap_b32 v8, v4
    s_nop 1
    v_max_f32 v4, v8, v4
    v_add_u32 v8, 0xffff, v4
    v_cmp_lt_f32 vcc, 0, v4
    s_nop 1
    v_cndmask_b32 v8, v4, v8, vcc
    v_lshrrev_b32 v8, 16, v8
    v_xor_b32 v8, 0x8000, v8
    v_cndmask_b32 v150, v150, v8, s[88:89]
    v_mov_b32 v8, v5
    s_nop 1
    v_permlane32_swap_b32 v8, v5
    s_nop 1
    v_max_f32 v5, v8, v5
    v_add_u32 v8, 0xffff, v5
    v_cmp_lt_f32 vcc, 0, v5
    s_nop 1
    v_cndmask_b32 v8, v5, v8, vcc
    v_lshrrev_b32 v8, 16, v8
    v_xor_b32 v8, 0x8000, v8
    v_cndmask_b32 v158, v158, v8, s[88:89]
    v_mov_b32 v8, v6
    s_nop 1
    v_permlane32_swap_b32 v8, v6
    s_nop 1
    v_max_f32 v6, v8, v6
    v_add_u32 v8, 0xffff, v6
    v_cmp_lt_f32 vcc, 0, v6
    s_nop 1
    v_cndmask_b32 v8, v6, v8, vcc
    v_lshrrev_b32 v8, 16, v8
    v_xor_b32 v8, 0x8000, v8
    v_cndmask_b32 v166, v166, v8, s[88:89]
    v_mov_b32 v8, v7
    s_nop 1
    v_permlane32_swap_b32 v8, v7
    s_nop 1
    v_max_f32 v7, v8, v7
    v_add_u32 v8, 0xffff, v7
    v_cmp_lt_f32 vcc, 0, v7
    s_nop 1
    v_cndmask_b32 v8, v7, v8, vcc
    v_lshrrev_b32 v8, 16, v8
    v_xor_b32 v8, 0x8000, v8
    v_cndmask_b32 v174, v174, v8, s[88:89]
    s_cmp_ge_u32 s3, 4
    s_cbranch_scc1 k2_noside2
    s_cmp_lg_u32 s95, 0
    s_cbranch_scc1 k2_noside2
    s_mov_b32 s95, 1
    s_waitcnt vmcnt(4)
    v_lshlrev_b32 v116, 16, v116
    v_lshlrev_b32 v117, 16, v117
    v_lshlrev_b32 v118, 16, v118
    v_mul_f32 v118, 0x3fb8aa3b, v118
    v_exp_f32 v118, v118
    s_nop 0
    v_cvt_pk_bf16_f32 v118, v118, v118
    v_lshlrev_b32 v118, 16, v118
    v_mul_f32 v119, v118, v116
    v_mul_f32 v120, v118, v117
    v_mul_f32 v119, 0x3fb8aa3b, v119
    v_mul_f32 v120, 0.15915494, v120
    v_exp_f32 v119, v119
    v_fract_f32 v120, v120
    v_cos_f32 v112, v120
    v_sin_f32 v113, v120
    s_nop 0
    v_mul_f32 v112, v112, v119
    v_mul_f32 v113, v113, v119
    v_mov_b32 v240, v112
    v_mov_b32 v241, v113
    v_pk_mul_f32 v[122:123], v[240:241], v[240:241] op_sel:[0,0] op_sel_hi:[0,1]
    v_pk_fma_f32 v[122:123], v[240:241], v[240:241], v[122:123] op_sel:[1,1,0] op_sel_hi:[1,0,1] neg_lo:[1,0,0]
    v_pk_mul_f32 v[124:125], v[122:123], v[122:123] op_sel:[0,0] op_sel_hi:[0,1]
    v_pk_fma_f32 v[124:125], v[122:123], v[122:123], v[124:125] op_sel:[1,1,0] op_sel_hi:[1,0,1] neg_lo:[1,0,0]
    v_pk_mul_f32 v[126:127], v[124:125], v[124:125] op_sel:[0,0] op_sel_hi:[0,1]
    v_pk_fma_f32 v[126:127], v[124:125], v[124:125], v[126:127] op_sel:[1,1,0] op_sel_hi:[1,0,1] neg_lo:[1,0,0]
    v_pk_mul_f32 v[128:129], v[126:127], v[126:127] op_sel:[0,0] op_sel_hi:[0,1]
    v_pk_fma_f32 v[128:129], v[126:127], v[126:127], v[128:129] op_sel:[1,1,0] op_sel_hi:[1,0,1] neg_lo:[1,0,0]
    v_pk_mul_f32 v[130:131], v[128:129], v[128:129] op_sel:[0,0] op_sel_hi:[0,1]
    v_pk_fma_f32 v[130:131], v[128:129], v[128:129], v[130:131] op_sel:[1,1,0] op_sel_hi:[1,0,1] neg_lo:[1,0,0]
    v_pk_mul_f32 v[132:133], v[130:131], v[130:131] op_sel:[0,0] op_sel_hi:[0,1]
    v_pk_fma_f32 v[132:133], v[130:131], v[130:131], v[132:133] op_sel:[1,1,0] op_sel_hi:[1,0,1] neg_lo:[1,0,0]
    v_pk_mul_f32 v[134:135], v[132:133], v[132:133] op_sel:[0,0] op_sel_hi:[0,1]
    v_pk_fma_f32 v[134:135], v[132:133], v[132:133], v[134:135] op_sel:[1,1,0] op_sel_hi:[1,0,1] neg_lo:[1,0,0]
    v_mov_b32 v136, 0
    v_mov_b32 v137, 0
    s_cmp_le_u32 s9, 0
    s_cbranch_scc1 k2_hdone
    v_pk_fma_f32 v[80:81], v[134:135], v[136:137], v[80:81] op_sel:[0,0,0] op_sel_hi:[0,1,1]
    v_pk_fma_f32 v[80:81], v[134:135], v[136:137], v[80:81] op_sel:[1,1,0] op_sel_hi:[1,0,1] neg_lo:[1,0,0]
    v_mov_b32 v136, v80
    v_mov_b32 v137, v81
    s_cmp_le_u32 s9, 1
    s_cbranch_scc1 k2_hdone
    v_pk_fma_f32 v[82:83], v[134:135], v[136:137], v[82:83] op_sel:[0,0,0] op_sel_hi:[0,1,1]
    v_pk_fma_f32 v[82:83], v[134:135], v[136:137], v[82:83] op_sel:[1,1,0] op_sel_hi:[1,0,1] neg_lo:[1,0,0]
    v_mov_b32 v136, v82
    v_mov_b32 v137, v83
    s_cmp_le_u32 s9, 2
    s_cbranch_scc1 k2_hdone
    v_pk_fma_f32 v[84:85], v[134:135], v[136:137], v[84:85] op_sel:[0,0,0] op_sel_hi:[0,1,1]
    v_pk_fma_f32 v[84:85], v[134:135], v[136:137], v[84:85] op_sel:[1,1,0] op_sel_hi:[1,0,1] neg_lo:[1,0,0]
    v_mov_b32 v136, v84
    v_mov_b32 v137, v85
    s_cmp_le_u32 s9, 3
    s_cbranch_scc1 k2_hdone
    v_pk_fma_f32 v[86:87], v[134:135], v[136:137], v[86:87] op_sel:[0,0,0] op_sel_hi:[0,1,1]
    v_pk_fma_f32 v[86:87], v[134:135], v[136:137], v[86:87] op_sel:[1,1,0] op_sel_hi:[1,0,1] neg_lo:[1,0,0]
    v_mov_b32 v136, v86
    v_mov_b32 v137, v87
    s_cmp_le_u32 s9, 4
    s_cbranch_scc1 k2_hdone
    v_pk_fma_f32 v[88:89], v[134:135], v[136:137], v[88:89] op_sel:[0,0,0] op_sel_hi:[0,1,1]
    v_pk_fma_f32 v[88:89], v[134:135], v[136:137], v[88:89] op_sel:[1,1,0] op_sel_hi:[1,0,1] neg_lo:[1,0,0]
    v_mov_b32 v136, v88
    v_mov_b32 v137, v89
    s_cmp_le_u32 s9, 5
    s_cbranch_scc1 k2_hdone
    v_pk_fma_f32 v[90:91], v[134:135], v[136:137], v[90:91] op_sel:[0,0,0] op_sel_hi:[0,1,1]
    v_pk_fma_f32 v[90:91], v[134:135], v[136:137], v[90:91] op_sel:[1,1,0] op_sel_hi:[1,0,1] neg_lo:[1,0,0]
    v_mov_b32 v136, v90
    v_mov_b32 v137, v91
    s_cmp_le_u32 s9, 6
    s_cbranch_scc1 k2_hdone
    v_pk_fma_f32 v[92:93], v[134:135], v[136:137], v[92:93] op_sel:[0,0,0] op_sel_hi:[0,1,1]
    v_pk_fma_f32 v[92:93], v[134:135], v[136:137], v[92:93] op_sel:[1,1,0] op_sel_hi:[1,0,1] neg_lo:[1,0,0]
    v_mov_b32 v136, v92
    v_mov_b32 v137, v93
    s_cmp_le_u32 s9, 7
    s_cbranch_scc1 k2_hdone
    v_pk_fma_f32 v[94:95], v[134:135], v[136:137], v[94:95] op_sel:[0,0,0] op_sel_hi:[0,1,1]
    v_pk_fma_f32 v[94:95], v[134:135], v[136:137], v[94:95] op_sel:[1,1,0] op_sel_hi:[1,0,1] neg_lo:[1,0,0]
    v_mov_b32 v136, v94
    v_mov_b32 v137, v95
    s_cmp_le_u32 s9, 8
    s_cbranch_scc1 k2_hdone
    v_pk_fma_f32 v[96:97], v[134:135], v[136:137], v[96:97] op_sel:[0,0,0] op_sel_hi:[0,1,1]
    v_pk_fma_f32 v[96:97], v[134:135], v[136:137], v[96:97] op_sel:[1,1,0] op_sel_hi:[1,0,1] neg_lo:[1,0,0]
    v_mov_b32 v136, v96
    v_mov_b32 v137, v97
    s_cmp_le_u32 s9, 9
    s_cbranch_scc1 k2_hdone
    v_pk_fma_f32 v[98:99], v[134:135], v[136:137], v[98:99] op_sel:[0,0,0] op_sel_hi:[0,1,1]
    v_pk_fma_f32 v[98:99], v[134:135], v[136:137], v[98:99] op_sel:[1,1,0] op_sel_hi:[1,0,1] neg_lo:[1,0,0]
    v_mov_b32 v136, v98
    v_mov_b32 v137, v99
    s_cmp_le_u32 s9, 10
    s_cbranch_scc1 k2_hdone
    v_pk_fma_f32 v[100:101], v[134:135], v[136:137], v[100:101] op_sel:[0,0,0] op_sel_hi:[0,1,1]
    v_pk_fma_f32 v[100:101], v[134:135], v[136:137], v[100:101] op_sel:[1,1,0] op_sel_hi:[1,0,1] neg_lo:[1,0,0]
    v_mov_b32 v136, v100
    v_mov_b32 v137, v101
    s_cmp_le_u32 s9, 11
    s_cbranch_scc1 k2_hdone
    v_pk_fma_f32 v[102:103], v[134:135], v[136:137], v[102:103] op_sel:[0,0,0] op_sel_hi:[0,1,1]
    v_pk_fma_f32 v[102:103], v[134:135], v[136:137], v[102:103] op_sel:[1,1,0] op_sel_hi:[1,0,1] neg_lo:[1,0,0]
    v_mov_b32 v136, v102
    v_mov_b32 v137, v103
    s_cmp_le_u32 s9, 12
    s_cbranch_scc1 k2_hdone
    v_pk_fma_f32 v[104:105], v[134:135], v[136:137], v[104:105] op_sel:[0,0,0] op_sel_hi:[0,1,1]
    v_pk_fma_f32 v[104:105], v[134:135], v[136:137], v[104:105] op_sel:[1,1,0] op_sel_hi:[1,0,1] neg_lo:[1,0,0]
    v_mov_b32 v136, v104
    v_mov_b32 v137, v105
    s_cmp_le_u32 s9, 13
    s_cbranch_scc1 k2_hdone
    v_pk_fma_f32 v[106:107], v[134:135], v[136:137], v[106:107] op_sel:[0,0,0] op_sel_hi:[0,1,1]
    v_pk_fma_f32 v[106:107], v[134:135], v[136:137], v[106:107] op_sel:[1,1,0] op_sel_hi:[1,0,1] neg_lo:[1,0,0]
    v_mov_b32 v136, v106
    v_mov_b32 v137, v107
    s_cmp_le_u32 s9, 14
    s_cbranch_scc1 k2_hdone
    v_pk_fma_f32 v[108:109], v[134:135], v[136:137], v[108:109] op_sel:[0,0,0] op_sel_hi:[0,1,1]
    v_pk_fma_f32 v[108:109], v[134:135], v[136:137], v[108:109] op_sel:[1,1,0] op_sel_hi:[1,0,1] neg_lo:[1,0,0]
    v_mov_b32 v136, v108
    v_mov_b32 v137, v109
k2_hdone:
    s_bitcmp0_b32 s6, 0
    s_cbranch_scc1 k2_pw1
    v_pk_mul_f32 v[138:139], v[128:129], v[136:137] op_sel:[0,0] op_sel_hi:[0,1]
    v_pk_fma_f32 v[138:139], v[128:129], v[136:137], v[138:139] op_sel:[1,1,0] op_sel_hi:[1,0,1] neg_lo:[1,0,0]
    v_mov_b32 v136, v138
    v_mov_b32 v137, v139
k2_pw1:
    s_bitcmp0_b32 s6, 1
    s_cbranch_scc1 k2_pw2
    v_pk_mul_f32 v[138:139], v[130:131], v[136:137] op_sel:[0,0] op_sel_hi:[0,1]
    v_pk_fma_f32 v[138:139], v[130:131], v[136:137], v[138:139] op_sel:[1,1,0] op_sel_hi:[1,0,1] neg_lo:[1,0,0]
    v_mov_b32 v136, v138
    v_mov_b32 v137, v139
k2_pw2:
    s_bitcmp0_b32 s6, 2
    s_cbranch_scc1 k2_pw4
    v_pk_mul_f32 v[138:139], v[132:133], v[136:137] op_sel:[0,0] op_sel_hi:[0,1]
    v_pk_fma_f32 v[138:139], v[132:133], v[136:137], v[138:139] op_sel:[1,1,0] op_sel_hi:[1,0,1] neg_lo:[1,0,0]
    v_mov_b32 v136, v138
    v_mov_b32 v137, v139
k2_pw4:
    v_pk_add_f32 v[242:243], v[242:243], v[136:137]
k2_noside2:
    s_add_u32 s15, s90, 0x200000
    buffer_load_dwordx4 v[48:51], v3, s[48:51], s90 offen
    buffer_load_dwordx4 v[52:55], v3, s[48:51], s90 offen offset:1024
    buffer_load_dwordx4 v[56:59], v3, s[48:51], s15 offen
    buffer_load_dwordx4 v[60:63], v3, s[48:51], s15 offen offset:1024
    s_add_u32 s90, s90, 2048
    s_add_u32 s15, s90, 0x200000
    buffer_load_dwordx4 v[64:67], v3, s[48:51], s90 offen
    buffer_load_dwordx4 v[68:71], v3, s[48:51], s90 offen offset:1024
    buffer_load_dwordx4 v[72:75], v3, s[48:51], s15 offen
    buffer_load_dwordx4 v[76:79], v3, s[48:51], s15 offen offset:1024
    s_add_u32 s90, s90, 2048
    s_waitcnt vmcnt(12)
    v_mfma_f32_32x32x16_bf16 v[176:191], v[16:19], v[144:147], 0
    v_mfma_f32_32x32x16_bf16 v[176:191], v[20:23], v[148:151], v[176:191]
    s_nop 15
    v_mfma_f32_32x32x16_bf16 v[192:207], v[16:19], v[152:155], 0
    v_exp_f32 v176, v176
    v_exp_f32 v177, v177
    v_exp_f32 v178, v178
    v_exp_f32 v179, v179
    v_exp_f32 v180, v180
    v_exp_f32 v181, v181
    v_exp_f32 v182, v182
    v_exp_f32 v183, v183
    v_mfma_f32_32x32x16_bf16 v[192:207], v[20:23], v[156:159], v[192:207]
    v_exp_f32 v184, v184
    v_exp_f32 v185, v185
    v_exp_f32 v186, v186
    v_exp_f32 v187, v187
    v_exp_f32 v188, v188
    v_exp_f32 v189, v189
    v_exp_f32 v190, v190
    v_exp_f32 v191, v191
    v_cvt_pk_bf16_f32 v208, v176, v177
    v_cvt_pk_bf16_f32 v209, v178, v179
    v_cvt_pk_bf16_f32 v210, v180, v181
    v_cvt_pk_bf16_f32 v211, v182, v183
    v_cvt_pk_bf16_f32 v212, v184, v185
    v_cvt_pk_bf16_f32 v213, v186, v187
    v_cvt_pk_bf16_f32 v214, v188, v189
    v_cvt_pk_bf16_f32 v215, v190, v191
    v_mfma_f32_32x32x16_bf16 v[176:191], v[16:19], v[160:163], 0
    v_exp_f32 v192, v192
    v_exp_f32 v193, v193
    v_exp_f32 v194, v194
    v_exp_f32 v195, v195
    v_mfma_f32_32x32x16_bf16 v[80:95], v[24:27], v[208:211], 0
    v_exp_f32 v196, v196
    v_exp_f32 v197, v197
    v_exp_f32 v198, v198
    v_exp_f32 v199, v199
    v_mfma_f32_32x32x16_bf16 v[176:191], v[20:23], v[164:167], v[176:191]
    v_exp_f32 v200, v200
    v_exp_f32 v201, v201
    v_exp_f32 v202, v202
    v_exp_f32 v203, v203
    v_mfma_f32_32x32x16_bf16 v[80:95], v[28:31], v[212:215], v[80:95]
    v_exp_f32 v204, v204
    v_exp_f32 v205, v205
    v_exp_f32 v206, v206
    v_exp_f32 v207, v207
    v_cvt_pk_bf16_f32 v216, v192, v193
    v_cvt_pk_bf16_f32 v217, v194, v195
    v_cvt_pk_bf16_f32 v218, v196, v197
    v_cvt_pk_bf16_f32 v219, v198, v199
    v_cvt_pk_bf16_f32 v220, v200, v201
    v_cvt_pk_bf16_f32 v221, v202, v203
    v_cvt_pk_bf16_f32 v222, v204, v205
    v_cvt_pk_bf16_f32 v223, v206, v207
    v_mfma_f32_32x32x16_bf16 v[192:207], v[16:19], v[168:171], 0
    v_exp_f32 v176, v176
    v_exp_f32 v177, v177
    v_exp_f32 v178, v178
    v_exp_f32 v179, v179
    v_mfma_f32_32x32x16_bf16 v[96:111], v[24:27], v[216:219], 0
    v_exp_f32 v180, v180
    v_exp_f32 v181, v181
    v_exp_f32 v182, v182
    v_exp_f32 v183, v183
    v_mfma_f32_32x32x16_bf16 v[192:207], v[20:23], v[172:175], v[192:207]
    v_exp_f32 v184, v184
    v_exp_f32 v185, v185
    v_exp_f32 v186, v186
    v_exp_f32 v187, v187
    v_mfma_f32_32x32x16_bf16 v[96:111], v[28:31], v[220:223], v[96:111]
    v_exp_f32 v188, v188
    v_exp_f32 v189, v189
    v_exp_f32 v190, v190
    v_exp_f32 v191, v191
    v_cvt_pk_bf16_f32 v208, v176, v177
    v_cvt_pk_bf16_f32 v209, v178, v179
    v_cvt_pk_bf16_f32 v210, v180, v181
    v_cvt_pk_bf16_f32 v211, v182, v183
    v_cvt_pk_bf16_f32 v212, v184, v185
    v_cvt_pk_bf16_f32 v213, v186, v187
    v_cvt_pk_bf16_f32 v214, v188, v189
    v_cvt_pk_bf16_f32 v215, v190, v191
    s_waitcnt vmcnt(8)
    v_mfma_f32_32x32x16_bf16 v[176:191], v[32:35], v[144:147], 0
    v_exp_f32 v192, v192
    v_exp_f32 v193, v193
    v_exp_f32 v194, v194
    v_exp_f32 v195, v195
    v_mfma_f32_32x32x16_bf16 v[112:127], v[24:27], v[208:211], 0
    v_exp_f32 v196, v196
    v_exp_f32 v197, v197
    v_exp_f32 v198, v198
    v_exp_f32 v199, v199
    v_mfma_f32_32x32x16_bf16 v[176:191], v[36:39], v[148:151], v[176:191]
    v_exp_f32 v200, v200
    v_exp_f32 v201, v201
    v_exp_f32 v202, v202
    v_exp_f32 v203, v203
    v_mfma_f32_32x32x16_bf16 v[112:127], v[28:31], v[212:215], v[112:127]
    v_exp_f32 v204, v204
    v_exp_f32 v205, v205
    v_exp_f32 v206, v206
    v_exp_f32 v207, v207
    v_cvt_pk_bf16_f32 v216, v192, v193
    v_cvt_pk_bf16_f32 v217, v194, v195
    v_cvt_pk_bf16_f32 v218, v196, v197
    v_cvt_pk_bf16_f32 v219, v198, v199
    v_cvt_pk_bf16_f32 v220, v200, v201
    v_cvt_pk_bf16_f32 v221, v202, v203
    v_cvt_pk_bf16_f32 v222, v204, v205
    v_cvt_pk_bf16_f32 v223, v206, v207
    v_mfma_f32_32x32x16_bf16 v[192:207], v[32:35], v[152:155], 0
    v_exp_f32 v176, v176
    v_exp_f32 v177, v177
    v_exp_f32 v178, v178
    v_exp_f32 v179, v179
    v_mfma_f32_32x32x16_bf16 v[128:143], v[24:27], v[216:219], 0
    v_exp_f32 v180, v180
    v_exp_f32 v181, v181
    v_exp_f32 v182, v182
    v_exp_f32 v183, v183
    v_mfma_f32_32x32x16_bf16 v[192:207], v[36:39], v[156:159], v[192:207]
    v_exp_f32 v184, v184
    v_exp_f32 v185, v185
    v_exp_f32 v186, v186
    v_exp_f32 v187, v187
    v_mfma_f32_32x32x16_bf16 v[128:143], v[28:31], v[220:223], v[128:143]
    s_add_u32 s15, s90, 0x200000
    buffer_load_dwordx4 v[16:19], v3, s[48:51], s90 offen
    buffer_load_dwordx4 v[20:23], v3, s[48:51], s90 offen offset:1024
    buffer_load_dwordx4 v[24:27], v3, s[48:51], s15 offen
    buffer_load_dwordx4 v[28:31], v3, s[48:51], s15 offen offset:1024
    s_add_u32 s90, s90, 2048
    v_exp_f32 v188, v188
    v_exp_f32 v189, v189
    v_exp_f32 v190, v190
    v_exp_f32 v191, v191
    v_cvt_pk_bf16_f32 v208, v176, v177
    v_cvt_pk_bf16_f32 v209, v178, v179
    v_cvt_pk_bf16_f32 v210, v180, v181
    v_cvt_pk_bf16_f32 v211, v182, v183
    v_cvt_pk_bf16_f32 v212, v184, v185
    v_cvt_pk_bf16_f32 v213, v186, v187
    v_cvt_pk_bf16_f32 v214, v188, v189
    v_cvt_pk_bf16_f32 v215, v190, v191
    v_mfma_f32_32x32x16_bf16 v[176:191], v[32:35], v[160:163], 0
    v_exp_f32 v192, v192
    v_exp_f32 v193, v193
    v_exp_f32 v194, v194
    v_exp_f32 v195, v195
    v_mfma_f32_32x32x16_bf16 v[80:95], v[40:43], v[208:211], v[80:95]
    v_exp_f32 v196, v196
    v_exp_f32 v197, v197
    v_exp_f32 v198, v198
    v_exp_f32 v199, v199
    v_mfma_f32_32x32x16_bf16 v[176:191], v[36:39], v[164:167], v[176:191]
    v_exp_f32 v200, v200
    v_exp_f32 v201, v201
    v_exp_f32 v202, v202
    v_exp_f32 v203, v203
    v_mfma_f32_32x32x16_bf16 v[80:95], v[44:47], v[212:215], v[80:95]
    v_exp_f32 v204, v204
    v_exp_f32 v205, v205
    v_exp_f32 v206, v206
    v_exp_f32 v207, v207
    v_cvt_pk_bf16_f32 v216, v192, v193
    v_cvt_pk_bf16_f32 v217, v194, v195
    v_cvt_pk_bf16_f32 v218, v196, v197
    v_cvt_pk_bf16_f32 v219, v198, v199
    v_cvt_pk_bf16_f32 v220, v200, v201
    v_cvt_pk_bf16_f32 v221, v202, v203
    v_cvt_pk_bf16_f32 v222, v204, v205
    v_cvt_pk_bf16_f32 v223, v206, v207
    v_mfma_f32_32x32x16_bf16 v[192:207], v[32:35], v[168:171], 0
    v_exp_f32 v176, v176
    v_exp_f32 v177, v177
    v_exp_f32 v178, v178
    v_exp_f32 v179, v179
    v_mfma_f32_32x32x16_bf16 v[96:111], v[40:43], v[216:219], v[96:111]
    v_exp_f32 v180, v180
    v_exp_f32 v181, v181
    v_exp_f32 v182, v182
    v_exp_f32 v183, v183
    v_mfma_f32_32x32x16_bf16 v[192:207], v[36:39], v[172:175], v[192:207]
    v_exp_f32 v184, v184
    v_exp_f32 v185, v185
    v_exp_f32 v186, v186
    v_exp_f32 v187, v187
    v_mfma_f32_32x32x16_bf16 v[96:111], v[44:47], v[220:223], v[96:111]
    v_exp_f32 v188, v188
    v_exp_f32 v189, v189
    v_exp_f32 v190, v190
    v_exp_f32 v191, v191
    v_cvt_pk_bf16_f32 v208, v176, v177
    v_cvt_pk_bf16_f32 v209, v178, v179
    v_cvt_pk_bf16_f32 v210, v180, v181
    v_cvt_pk_bf16_f32 v211, v182, v183
    v_cvt_pk_bf16_f32 v212, v184, v185
    v_cvt_pk_bf16_f32 v213, v186, v187
    v_cvt_pk_bf16_f32 v214, v188, v189
    v_cvt_pk_bf16_f32 v215, v190, v191
    s_waitcnt vmcnt(8)
    v_mfma_f32_32x32x16_bf16 v[176:191], v[48:51], v[144:147], 0
    v_exp_f32 v192, v192
    v_exp_f32 v193, v193
    v_exp_f32 v194, v194
    v_exp_f32 v195, v195
    v_mfma_f32_32x32x16_bf16 v[112:127], v[40:43], v[208:211], v[112:127]
    v_exp_f32 v196, v196
    v_exp_f32 v197, v197
    v_exp_f32 v198, v198
    v_exp_f32 v199, v199
    v_mfma_f32_32x32x16_bf16 v[176:191], v[52:55], v[148:151], v[176:191]
    v_exp_f32 v200, v200
    v_exp_f32 v201, v201
    v_exp_f32 v202, v202
    v_exp_f32 v203, v203
    v_mfma_f32_32x32x16_bf16 v[112:127], v[44:47], v[212:215], v[112:127]
    v_exp_f32 v204, v204
    v_exp_f32 v205, v205
    v_exp_f32 v206, v206
    v_exp_f32 v207, v207
    v_cvt_pk_bf16_f32 v216, v192, v193
    v_cvt_pk_bf16_f32 v217, v194, v195
    v_cvt_pk_bf16_f32 v218, v196, v197
    v_cvt_pk_bf16_f32 v219, v198, v199
    v_cvt_pk_bf16_f32 v220, v200, v201
    v_cvt_pk_bf16_f32 v221, v202, v203
    v_cvt_pk_bf16_f32 v222, v204, v205
    v_cvt_pk_bf16_f32 v223, v206, v207
    v_mfma_f32_32x32x16_bf16 v[192:207], v[48:51], v[152:155], 0
    v_exp_f32 v176, v176
    v_exp_f32 v177, v177
    v_exp_f32 v178, v178
    v_exp_f32 v179, v179
    v_mfma_f32_32x32x16_bf16 v[128:143], v[40:43], v[216:219], v[128:143]
    v_exp_f32 v180, v180
    v_exp_f32 v181, v181
    v_exp_f32 v182, v182
    v_exp_f32 v183, v183
    v_mfma_f32_32x32x16_bf16 v[192:207], v[52:55], v[156:159], v[192:207]
    v_exp_f32 v184, v184
    v_exp_f32 v185, v185
    v_exp_f32 v186, v186
    v_exp_f32 v187, v187
    v_mfma_f32_32x32x16_bf16 v[128:143], v[44:47], v[220:223], v[128:143]
    s_add_u32 s15, s90, 0x200000
    buffer_load_dwordx4 v[32:35], v3, s[48:51], s90 offen
    buffer_load_dwordx4 v[36:39], v3, s[48:51], s90 offen offset:1024
    buffer_load_dwordx4 v[40:43], v3, s[48:51], s15 offen
    buffer_load_dwordx4 v[44:47], v3, s[48:51], s15 offen offset:1024
    s_add_u32 s90, s90, 2048
    v_exp_f32 v188, v188
    v_exp_f32 v189, v189
    v_exp_f32 v190, v190
    v_exp_f32 v191, v191
    v_cvt_pk_bf16_f32 v208, v176, v177
    v_cvt_pk_bf16_f32 v209, v178, v179
    v_cvt_pk_bf16_f32 v210, v180, v181
    v_cvt_pk_bf16_f32 v211, v182, v183
    v_cvt_pk_bf16_f32 v212, v184, v185
    v_cvt_pk_bf16_f32 v213, v186, v187
    v_cvt_pk_bf16_f32 v214, v188, v189
    v_cvt_pk_bf16_f32 v215, v190, v191
    v_mfma_f32_32x32x16_bf16 v[176:191], v[48:51], v[160:163], 0
    v_exp_f32 v192, v192
    v_exp_f32 v193, v193
    v_exp_f32 v194, v194
    v_exp_f32 v195, v195
    v_mfma_f32_32x32x16_bf16 v[80:95], v[56:59], v[208:211], v[80:95]
    v_exp_f32 v196, v196
    v_exp_f32 v197, v197
    v_exp_f32 v198, v198
    v_exp_f32 v199, v199
    v_mfma_f32_32x32x16_bf16 v[176:191], v[52:55], v[164:167], v[176:191]
    v_exp_f32 v200, v200
    v_exp_f32 v201, v201
    v_exp_f32 v202, v202
    v_exp_f32 v203, v203
    v_mfma_f32_32x32x16_bf16 v[80:95], v[60:63], v[212:215], v[80:95]
    v_exp_f32 v204, v204
    v_exp_f32 v205, v205
    v_exp_f32 v206, v206
    v_exp_f32 v207, v207
    v_cvt_pk_bf16_f32 v216, v192, v193
    v_cvt_pk_bf16_f32 v217, v194, v195
    v_cvt_pk_bf16_f32 v218, v196, v197
    v_cvt_pk_bf16_f32 v219, v198, v199
    v_cvt_pk_bf16_f32 v220, v200, v201
    v_cvt_pk_bf16_f32 v221, v202, v203
    v_cvt_pk_bf16_f32 v222, v204, v205
    v_cvt_pk_bf16_f32 v223, v206, v207
    v_mfma_f32_32x32x16_bf16 v[192:207], v[48:51], v[168:171], 0
    v_exp_f32 v176, v176
    v_exp_f32 v177, v177
    v_exp_f32 v178, v178
    v_exp_f32 v179, v179
    v_mfma_f32_32x32x16_bf16 v[96:111], v[56:59], v[216:219], v[96:111]
    v_exp_f32 v180, v180
    v_exp_f32 v181, v181
    v_exp_f32 v182, v182
    v_exp_f32 v183, v183
    v_mfma_f32_32x32x16_bf16 v[192:207], v[52:55], v[172:175], v[192:207]
    v_exp_f32 v184, v184
    v_exp_f32 v185, v185
    v_exp_f32 v186, v186
    v_exp_f32 v187, v187
    v_mfma_f32_32x32x16_bf16 v[96:111], v[60:63], v[220:223], v[96:111]
    v_exp_f32 v188, v188
    v_exp_f32 v189, v189
    v_exp_f32 v190, v190
    v_exp_f32 v191, v191
    v_cvt_pk_bf16_f32 v208, v176, v177
    v_cvt_pk_bf16_f32 v209, v178, v179
    v_cvt_pk_bf16_f32 v210, v180, v181
    v_cvt_pk_bf16_f32 v211, v182, v183
    v_cvt_pk_bf16_f32 v212, v184, v185
    v_cvt_pk_bf16_f32 v213, v186, v187
    v_cvt_pk_bf16_f32 v214, v188, v189
    v_cvt_pk_bf16_f32 v215, v190, v191
    s_waitcnt vmcnt(8)
    v_mfma_f32_32x32x16_bf16 v[176:191], v[64:67], v[144:147], 0
    v_exp_f32 v192, v192
    v_exp_f32 v193, v193
    v_exp_f32 v194, v194
    v_exp_f32 v195, v195
    v_mfma_f32_32x32x16_bf16 v[112:127], v[56:59], v[208:211], v[112:127]
    v_exp_f32 v196, v196
    v_exp_f32 v197, v197
    v_exp_f32 v198, v198
    v_exp_f32 v199, v199
    v_mfma_f32_32x32x16_bf16 v[176:191], v[68:71], v[148:151], v[176:191]
    v_exp_f32 v200, v200
    v_exp_f32 v201, v201
    v_exp_f32 v202, v202
    v_exp_f32 v203, v203
    v_mfma_f32_32x32x16_bf16 v[112:127], v[60:63], v[212:215], v[112:127]
    v_exp_f32 v204, v204
    v_exp_f32 v205, v205
    v_exp_f32 v206, v206
    v_exp_f32 v207, v207
    v_cvt_pk_bf16_f32 v216, v192, v193
    v_cvt_pk_bf16_f32 v217, v194, v195
    v_cvt_pk_bf16_f32 v218, v196, v197
    v_cvt_pk_bf16_f32 v219, v198, v199
    v_cvt_pk_bf16_f32 v220, v200, v201
    v_cvt_pk_bf16_f32 v221, v202, v203
    v_cvt_pk_bf16_f32 v222, v204, v205
    v_cvt_pk_bf16_f32 v223, v206, v207
    v_mfma_f32_32x32x16_bf16 v[192:207], v[64:67], v[152:155], 0
    v_exp_f32 v176, v176
    v_exp_f32 v177, v177
    v_exp_f32 v178, v178
    v_exp_f32 v179, v179
    v_mfma_f32_32x32x16_bf16 v[128:143], v[56:59], v[216:219], v[128:143]
    v_exp_f32 v180, v180
    v_exp_f32 v181, v181
    v_exp_f32 v182, v182
    v_exp_f32 v183, v183
    v_mfma_f32_32x32x16_bf16 v[192:207], v[68:71], v[156:159], v[192:207]
    v_exp_f32 v184, v184
    v_exp_f32 v185, v185
    v_exp_f32 v186, v186
    v_exp_f32 v187, v187
    v_mfma_f32_32x32x16_bf16 v[128:143], v[60:63], v[220:223], v[128:143]
    s_add_u32 s15, s90, 0x200000
    buffer_load_dwordx4 v[48:51], v3, s[48:51], s90 offen
    buffer_load_dwordx4 v[52:55], v3, s[48:51], s90 offen offset:1024
    buffer_load_dwordx4 v[56:59], v3, s[48:51], s15 offen
    buffer_load_dwordx4 v[60:63], v3, s[48:51], s15 offen offset:1024
    s_add_u32 s90, s90, 2048
    v_exp_f32 v188, v188
    v_exp_f32 v189, v189
    v_exp_f32 v190, v190
    v_exp_f32 v191, v191
    v_cvt_pk_bf16_f32 v208, v176, v177
    v_cvt_pk_bf16_f32 v209, v178, v179
    v_cvt_pk_bf16_f32 v210, v180, v181
    v_cvt_pk_bf16_f32 v211, v182, v183
    v_cvt_pk_bf16_f32 v212, v184, v185
    v_cvt_pk_bf16_f32 v213, v186, v187
    v_cvt_pk_bf16_f32 v214, v188, v189
    v_cvt_pk_bf16_f32 v215, v190, v191
    v_mfma_f32_32x32x16_bf16 v[176:191], v[64:67], v[160:163], 0
    v_exp_f32 v192, v192
    v_exp_f32 v193, v193
    v_exp_f32 v194, v194
    v_exp_f32 v195, v195
    v_mfma_f32_32x32x16_bf16 v[80:95], v[72:75], v[208:211], v[80:95]
    v_exp_f32 v196, v196
    v_exp_f32 v197, v197
    v_exp_f32 v198, v198
    v_exp_f32 v199, v199
    v_mfma_f32_32x32x16_bf16 v[176:191], v[68:71], v[164:167], v[176:191]
    v_exp_f32 v200, v200
    v_exp_f32 v201, v201
    v_exp_f32 v202, v202
    v_exp_f32 v203, v203
    v_mfma_f32_32x32x16_bf16 v[80:95], v[76:79], v[212:215], v[80:95]
    v_exp_f32 v204, v204
    v_exp_f32 v205, v205
    v_exp_f32 v206, v206
    v_exp_f32 v207, v207
    v_cvt_pk_bf16_f32 v216, v192, v193
    v_cvt_pk_bf16_f32 v217, v194, v195
    v_cvt_pk_bf16_f32 v218, v196, v197
    v_cvt_pk_bf16_f32 v219, v198, v199
    v_cvt_pk_bf16_f32 v220, v200, v201
    v_cvt_pk_bf16_f32 v221, v202, v203
    v_cvt_pk_bf16_f32 v222, v204, v205
    v_cvt_pk_bf16_f32 v223, v206, v207
    v_mfma_f32_32x32x16_bf16 v[192:207], v[64:67], v[168:171], 0
    v_exp_f32 v176, v176
    v_exp_f32 v177, v177
    v_exp_f32 v178, v178
    v_exp_f32 v179, v179
    v_mfma_f32_32x32x16_bf16 v[96:111], v[72:75], v[216:219], v[96:111]
    v_exp_f32 v180, v180
    v_exp_f32 v181, v181
    v_exp_f32 v182, v182
    v_exp_f32 v183, v183
    v_mfma_f32_32x32x16_bf16 v[192:207], v[68:71], v[172:175], v[192:207]
    v_exp_f32 v184, v184
    v_exp_f32 v185, v185
    v_exp_f32 v186, v186
    v_exp_f32 v187, v187
    v_mfma_f32_32x32x16_bf16 v[96:111], v[76:79], v[220:223], v[96:111]
    v_exp_f32 v188, v188
    v_exp_f32 v189, v189
    v_exp_f32 v190, v190
    v_exp_f32 v191, v191
    v_cvt_pk_bf16_f32 v208, v176, v177
    v_cvt_pk_bf16_f32 v209, v178, v179
    v_cvt_pk_bf16_f32 v210, v180, v181
    v_cvt_pk_bf16_f32 v211, v182, v183
    v_cvt_pk_bf16_f32 v212, v184, v185
    v_cvt_pk_bf16_f32 v213, v186, v187
    v_cvt_pk_bf16_f32 v214, v188, v189
    v_cvt_pk_bf16_f32 v215, v190, v191
    s_waitcnt vmcnt(8)
    v_mfma_f32_32x32x16_bf16 v[176:191], v[16:19], v[144:147], 0
    v_exp_f32 v192, v192
    v_exp_f32 v193, v193
    v_exp_f32 v194, v194
    v_exp_f32 v195, v195
    v_mfma_f32_32x32x16_bf16 v[112:127], v[72:75], v[208:211], v[112:127]
    v_exp_f32 v196, v196
    v_exp_f32 v197, v197
    v_exp_f32 v198, v198
    v_exp_f32 v199, v199
    v_mfma_f32_32x32x16_bf16 v[176:191], v[20:23], v[148:151], v[176:191]
    v_exp_f32 v200, v200
    v_exp_f32 v201, v201
    v_exp_f32 v202, v202
    v_exp_f32 v203, v203
    v_mfma_f32_32x32x16_bf16 v[112:127], v[76:79], v[212:215], v[112:127]
    v_exp_f32 v204, v204
    v_exp_f32 v205, v205
    v_exp_f32 v206, v206
    v_exp_f32 v207, v207
    v_cvt_pk_bf16_f32 v216, v192, v193
    v_cvt_pk_bf16_f32 v217, v194, v195
    v_cvt_pk_bf16_f32 v218, v196, v197
    v_cvt_pk_bf16_f32 v219, v198, v199
    v_cvt_pk_bf16_f32 v220, v200, v201
    v_cvt_pk_bf16_f32 v221, v202, v203
    v_cvt_pk_bf16_f32 v222, v204, v205
    v_cvt_pk_bf16_f32 v223, v206, v207
    v_mfma_f32_32x32x16_bf16 v[192:207], v[16:19], v[152:155], 0
    v_exp_f32 v176, v176
    v_exp_f32 v177, v177
    v_exp_f32 v178, v178
    v_exp_f32 v179, v179
    v_mfma_f32_32x32x16_bf16 v[128:143], v[72:75], v[216:219], v[128:143]
    v_exp_f32 v180, v180
    v_exp_f32 v181, v181
    v_exp_f32 v182, v182
    v_exp_f32 v183, v183
    v_mfma_f32_32x32x16_bf16 v[192:207], v[20:23], v[156:159], v[192:207]
    v_exp_f32 v184, v184
    v_exp_f32 v185, v185
    v_exp_f32 v186, v186
    v_exp_f32 v187, v187
    v_mfma_f32_32x32x16_bf16 v[128:143], v[76:79], v[220:223], v[128:143]
    s_add_u32 s15, s90, 0x200000
    buffer_load_dwordx4 v[64:67], v3, s[48:51], s90 offen
    buffer_load_dwordx4 v[68:71], v3, s[48:51], s90 offen offset:1024
    buffer_load_dwordx4 v[72:75], v3, s[48:51], s15 offen
    buffer_load_dwordx4 v[76:79], v3, s[48:51], s15 offen offset:1024
    s_add_u32 s90, s90, 2048
    v_exp_f32 v188, v188
    v_exp_f32 v189, v189
    v_exp_f32 v190, v190
    v_exp_f32 v191, v191
    v_cvt_pk_bf16_f32 v208, v176, v177
    v_cvt_pk_bf16_f32 v209, v178, v179
    v_cvt_pk_bf16_f32 v210, v180, v181
    v_cvt_pk_bf16_f32 v211, v182, v183
    v_cvt_pk_bf16_f32 v212, v184, v185
    v_cvt_pk_bf16_f32 v213, v186, v187
    v_cvt_pk_bf16_f32 v214, v188, v189
    v_cvt_pk_bf16_f32 v215, v190, v191
    v_mfma_f32_32x32x16_bf16 v[176:191], v[16:19], v[160:163], 0
    v_exp_f32 v192, v192
    v_exp_f32 v193, v193
    v_exp_f32 v194, v194
    v_exp_f32 v195, v195
    v_mfma_f32_32x32x16_bf16 v[80:95], v[24:27], v[208:211], v[80:95]
    v_exp_f32 v196, v196
    v_exp_f32 v197, v197
    v_exp_f32 v198, v198
    v_exp_f32 v199, v199
    v_mfma_f32_32x32x16_bf16 v[176:191], v[20:23], v[164:167], v[176:191]
    v_exp_f32 v200, v200
    v_exp_f32 v201, v201
    v_exp_f32 v202, v202
    v_exp_f32 v203, v203
    v_mfma_f32_32x32x16_bf16 v[80:95], v[28:31], v[212:215], v[80:95]
    v_exp_f32 v204, v204
    v_exp_f32 v205, v205
    v_exp_f32 v206, v206
    v_exp_f32 v207, v207
    v_cvt_pk_bf16_f32 v216, v192, v193
    v_cvt_pk_bf16_f32 v217, v194, v195
    v_cvt_pk_bf16_f32 v218, v196, v197
    v_cvt_pk_bf16_f32 v219, v198, v199
    v_cvt_pk_bf16_f32 v220, v200, v201
    v_cvt_pk_bf16_f32 v221, v202, v203
    v_cvt_pk_bf16_f32 v222, v204, v205
    v_cvt_pk_bf16_f32 v223, v206, v207
    v_mfma_f32_32x32x16_bf16 v[192:207], v[16:19], v[168:171], 0
    v_exp_f32 v176, v176
    v_exp_f32 v177, v177
    v_exp_f32 v178, v178
    v_exp_f32 v179, v179
    v_mfma_f32_32x32x16_bf16 v[96:111], v[24:27], v[216:219], v[96:111]
    v_exp_f32 v180, v180
    v_exp_f32 v181, v181
    v_exp_f32 v182, v182
    v_exp_f32 v183, v183
    v_mfma_f32_32x32x16_bf16 v[192:207], v[20:23], v[172:175], v[192:207]
    v_exp_f32 v184, v184
    v_exp_f32 v185, v185
    v_exp_f32 v186, v186
    v_exp_f32 v187, v187
    v_mfma_f32_32x32x16_bf16 v[96:111], v[28:31], v[220:223], v[96:111]
    v_exp_f32 v188, v188
    v_exp_f32 v189, v189
    v_exp_f32 v190, v190
    v_exp_f32 v191, v191
    v_cvt_pk_bf16_f32 v208, v176, v177
    v_cvt_pk_bf16_f32 v209, v178, v179
    v_cvt_pk_bf16_f32 v210, v180, v181
    v_cvt_pk_bf16_f32 v211, v182, v183
    v_cvt_pk_bf16_f32 v212, v184, v185
    v_cvt_pk_bf16_f32 v213, v186, v187
    v_cvt_pk_bf16_f32 v214, v188, v189
    v_cvt_pk_bf16_f32 v215, v190, v191
    s_waitcnt vmcnt(8)
    v_mfma_f32_32x32x16_bf16 v[176:191], v[32:35], v[144:147], 0
    v_exp_f32 v192, v192
    v_exp_f32 v193, v193
    v_exp_f32 v194, v194
    v_exp_f32 v195, v195
    v_mfma_f32_32x32x16_bf16 v[112:127], v[24:27], v[208:211], v[112:127]
    v_exp_f32 v196, v196
    v_exp_f32 v197, v197
    v_exp_f32 v198, v198
    v_exp_f32 v199, v199
    v_mfma_f32_32x32x16_bf16 v[176:191], v[36:39], v[148:151], v[176:191]
    v_exp_f32 v200, v200
    v_exp_f32 v201, v201
    v_exp_f32 v202, v202
    v_exp_f32 v203, v203
    v_mfma_f32_32x32x16_bf16 v[112:127], v[28:31], v[212:215], v[112:127]
    v_exp_f32 v204, v204
    v_exp_f32 v205, v205
    v_exp_f32 v206, v206
    v_exp_f32 v207, v207
    v_cvt_pk_bf16_f32 v216, v192, v193
    v_cvt_pk_bf16_f32 v217, v194, v195
    v_cvt_pk_bf16_f32 v218, v196, v197
    v_cvt_pk_bf16_f32 v219, v198, v199
    v_cvt_pk_bf16_f32 v220, v200, v201
    v_cvt_pk_bf16_f32 v221, v202, v203
    v_cvt_pk_bf16_f32 v222, v204, v205
    v_cvt_pk_bf16_f32 v223, v206, v207
    v_mfma_f32_32x32x16_bf16 v[192:207], v[32:35], v[152:155], 0
    v_exp_f32 v176, v176
    v_exp_f32 v177, v177
    v_exp_f32 v178, v178
    v_exp_f32 v179, v179
    v_mfma_f32_32x32x16_bf16 v[128:143], v[24:27], v[216:219], v[128:143]
    v_exp_f32 v180, v180
    v_exp_f32 v181, v181
    v_exp_f32 v182, v182
    v_exp_f32 v183, v183
    v_mfma_f32_32x32x16_bf16 v[192:207], v[36:39], v[156:159], v[192:207]
    v_exp_f32 v184, v184
    v_exp_f32 v185, v185
    v_exp_f32 v186, v186
    v_exp_f32 v187, v187
    v_mfma_f32_32x32x16_bf16 v[128:143], v[28:31], v[220:223], v[128:143]
    v_exp_f32 v188, v188
    v_exp_f32 v189, v189
    v_exp_f32 v190, v190
    v_exp_f32 v191, v191
    v_cvt_pk_bf16_f32 v208, v176, v177
    v_cvt_pk_bf16_f32 v209, v178, v179
    v_cvt_pk_bf16_f32 v210, v180, v181
    v_cvt_pk_bf16_f32 v211, v182, v183
    v_cvt_pk_bf16_f32 v212, v184, v185
    v_cvt_pk_bf16_f32 v213, v186, v187
    v_cvt_pk_bf16_f32 v214, v188, v189
    v_cvt_pk_bf16_f32 v215, v190, v191
    v_mfma_f32_32x32x16_bf16 v[176:191], v[32:35], v[160:163], 0
    v_exp_f32 v192, v192
    v_exp_f32 v193, v193
    v_exp_f32 v194, v194
    v_exp_f32 v195, v195
    v_mfma_f32_32x32x16_bf16 v[80:95], v[40:43], v[208:211], v[80:95]
    v_exp_f32 v196, v196
    v_exp_f32 v197, v197
    v_exp_f32 v198, v198
    v_exp_f32 v199, v199
    v_mfma_f32_32x32x16_bf16 v[176:191], v[36:39], v[164:167], v[176:191]
    v_exp_f32 v200, v200
    v_exp_f32 v201, v201
    v_exp_f32 v202, v202
    v_exp_f32 v203, v203
    v_mfma_f32_32x32x16_bf16 v[80:95], v[44:47], v[212:215], v[80:95]
    v_exp_f32 v204, v204
    v_exp_f32 v205, v205
    v_exp_f32 v206, v206
    v_exp_f32 v207, v207
    v_cvt_pk_bf16_f32 v216, v192, v193
    v_cvt_pk_bf16_f32 v217, v194, v195
    v_cvt_pk_bf16_f32 v218, v196, v197
    v_cvt_pk_bf16_f32 v219, v198, v199
    v_cvt_pk_bf16_f32 v220, v200, v201
    v_cvt_pk_bf16_f32 v221, v202, v203
    v_cvt_pk_bf16_f32 v222, v204, v205
    v_cvt_pk_bf16_f32 v223, v206, v207
    v_mfma_f32_32x32x16_bf16 v[192:207], v[32:35], v[168:171], 0
    v_exp_f32 v176, v176
    v_exp_f32 v177, v177
    v_exp_f32 v178, v178
    v_exp_f32 v179, v179
    v_mfma_f32_32x32x16_bf16 v[96:111], v[40:43], v[216:219], v[96:111]
    v_exp_f32 v180, v180
    v_exp_f32 v181, v181
    v_exp_f32 v182, v182
    v_exp_f32 v183, v183
    v_mfma_f32_32x32x16_bf16 v[192:207], v[36:39], v[172:175], v[192:207]
    v_exp_f32 v184, v184
    v_exp_f32 v185, v185
    v_exp_f32 v186, v186
    v_exp_f32 v187, v187
    v_mfma_f32_32x32x16_bf16 v[96:111], v[44:47], v[220:223], v[96:111]
    v_exp_f32 v188, v188
    v_exp_f32 v189, v189
    v_exp_f32 v190, v190
    v_exp_f32 v191, v191
    v_cvt_pk_bf16_f32 v208, v176, v177
    v_cvt_pk_bf16_f32 v209, v178, v179
    v_cvt_pk_bf16_f32 v210, v180, v181
    v_cvt_pk_bf16_f32 v211, v182, v183
    v_cvt_pk_bf16_f32 v212, v184, v185
    v_cvt_pk_bf16_f32 v213, v186, v187
    v_cvt_pk_bf16_f32 v214, v188, v189
    v_cvt_pk_bf16_f32 v215, v190, v191
    s_waitcnt vmcnt(4)
    v_mfma_f32_32x32x16_bf16 v[176:191], v[48:51], v[144:147], 0
    v_exp_f32 v192, v192
    v_exp_f32 v193, v193
    v_exp_f32 v194, v194
    v_exp_f32 v195, v195
    v_mfma_f32_32x32x16_bf16 v[112:127], v[40:43], v[208:211], v[112:127]
    v_exp_f32 v196, v196
    v_exp_f32 v197, v197
    v_exp_f32 v198, v198
    v_exp_f32 v199, v199
    v_mfma_f32_32x32x16_bf16 v[176:191], v[52:55], v[148:151], v[176:191]
    v_exp_f32 v200, v200
    v_exp_f32 v201, v201
    v_exp_f32 v202, v202
    v_exp_f32 v203, v203
    v_mfma_f32_32x32x16_bf16 v[112:127], v[44:47], v[212:215], v[112:127]
    v_exp_f32 v204, v204
    v_exp_f32 v205, v205
    v_exp_f32 v206, v206
    v_exp_f32 v207, v207
    v_cvt_pk_bf16_f32 v216, v192, v193
    v_cvt_pk_bf16_f32 v217, v194, v195
    v_cvt_pk_bf16_f32 v218, v196, v197
    v_cvt_pk_bf16_f32 v219, v198, v199
    v_cvt_pk_bf16_f32 v220, v200, v201
    v_cvt_pk_bf16_f32 v221, v202, v203
    v_cvt_pk_bf16_f32 v222, v204, v205
    v_cvt_pk_bf16_f32 v223, v206, v207
    v_mfma_f32_32x32x16_bf16 v[192:207], v[48:51], v[152:155], 0
    v_exp_f32 v176, v176
    v_exp_f32 v177, v177
    v_exp_f32 v178, v178
    v_exp_f32 v179, v179
    v_mfma_f32_32x32x16_bf16 v[128:143], v[40:43], v[216:219], v[128:143]
    v_exp_f32 v180, v180
    v_exp_f32 v181, v181
    v_exp_f32 v182, v182
    v_exp_f32 v183, v183
    v_mfma_f32_32x32x16_bf16 v[192:207], v[52:55], v[156:159], v[192:207]
    v_exp_f32 v184, v184
    v_exp_f32 v185, v185
    v_exp_f32 v186, v186
    v_exp_f32 v187, v187
    v_mfma_f32_32x32x16_bf16 v[128:143], v[44:47], v[220:223], v[128:143]
    v_exp_f32 v188, v188
    v_exp_f32 v189, v189
    v_exp_f32 v190, v190
    v_exp_f32 v191, v191
    v_cvt_pk_bf16_f32 v208, v176, v177
    v_cvt_pk_bf16_f32 v209, v178, v179
    v_cvt_pk_bf16_f32 v210, v180, v181
    v_cvt_pk_bf16_f32 v211, v182, v183
    v_cvt_pk_bf16_f32 v212, v184, v185
    v_cvt_pk_bf16_f32 v213, v186, v187
    v_cvt_pk_bf16_f32 v214, v188, v189
    v_cvt_pk_bf16_f32 v215, v190, v191
    v_mfma_f32_32x32x16_bf16 v[176:191], v[48:51], v[160:163], 0
    v_exp_f32 v192, v192
    v_exp_f32 v193, v193
    v_exp_f32 v194, v194
    v_exp_f32 v195, v195
    v_mfma_f32_32x32x16_bf16 v[80:95], v[56:59], v[208:211], v[80:95]
    v_exp_f32 v196, v196
    v_exp_f32 v197, v197
    v_exp_f32 v198, v198
    v_exp_f32 v199, v199
    v_mfma_f32_32x32x16_bf16 v[176:191], v[52:55], v[164:167], v[176:191]
    v_exp_f32 v200, v200
    v_exp_f32 v201, v201
    v_exp_f32 v202, v202
    v_exp_f32 v203, v203
    v_mfma_f32_32x32x16_bf16 v[80:95], v[60:63], v[212:215], v[80:95]
    v_exp_f32 v204, v204
    v_exp_f32 v205, v205
    v_exp_f32 v206, v206
    v_exp_f32 v207, v207
    v_cvt_pk_bf16_f32 v216, v192, v193
    v_cvt_pk_bf16_f32 v217, v194, v195
    v_cvt_pk_bf16_f32 v218, v196, v197
    v_cvt_pk_bf16_f32 v219, v198, v199
    v_cvt_pk_bf16_f32 v220, v200, v201
    v_cvt_pk_bf16_f32 v221, v202, v203
    v_cvt_pk_bf16_f32 v222, v204, v205
    v_cvt_pk_bf16_f32 v223, v206, v207
    v_mfma_f32_32x32x16_bf16 v[192:207], v[48:51], v[168:171], 0
    v_exp_f32 v176, v176
    v_exp_f32 v177, v177
    v_exp_f32 v178, v178
    v_exp_f32 v179, v179
    v_mfma_f32_32x32x16_bf16 v[96:111], v[56:59], v[216:219], v[96:111]
    v_exp_f32 v180, v180
    v_exp_f32 v181, v181
    v_exp_f32 v182, v182
    v_exp_f32 v183, v183
    v_mfma_f32_32x32x16_bf16 v[192:207], v[52:55], v[172:175], v[192:207]
    v_exp_f32 v184, v184
    v_exp_f32 v185, v185
    v_exp_f32 v186, v186
    v_exp_f32 v187, v187
    v_mfma_f32_32x32x16_bf16 v[96:111], v[60:63], v[220:223], v[96:111]
    v_exp_f32 v188, v188
    v_exp_f32 v189, v189
    v_exp_f32 v190, v190
    v_exp_f32 v191, v191
    v_cvt_pk_bf16_f32 v208, v176, v177
    v_cvt_pk_bf16_f32 v209, v178, v179
    v_cvt_pk_bf16_f32 v210, v180, v181
    v_cvt_pk_bf16_f32 v211, v182, v183
    v_cvt_pk_bf16_f32 v212, v184, v185
    v_cvt_pk_bf16_f32 v213, v186, v187
    v_cvt_pk_bf16_f32 v214, v188, v189
    v_cvt_pk_bf16_f32 v215, v190, v191
    s_waitcnt vmcnt(0)
    v_mfma_f32_32x32x16_bf16 v[176:191], v[64:67], v[144:147], 0
    v_exp_f32 v192, v192
    v_exp_f32 v193, v193
    v_exp_f32 v194, v194
    v_exp_f32 v195, v195
    v_mfma_f32_32x32x16_bf16 v[112:127], v[56:59], v[208:211], v[112:127]
    v_exp_f32 v196, v196
    v_exp_f32 v197, v197
    v_exp_f32 v198, v198
    v_exp_f32 v199, v199
    v_mfma_f32_32x32x16_bf16 v[176:191], v[68:71], v[148:151], v[176:191]
    v_exp_f32 v200, v200
    v_exp_f32 v201, v201
    v_exp_f32 v202, v202
    v_exp_f32 v203, v203
    v_mfma_f32_32x32x16_bf16 v[112:127], v[60:63], v[212:215], v[112:127]
    v_exp_f32 v204, v204
    v_exp_f32 v205, v205
    v_exp_f32 v206, v206
    v_exp_f32 v207, v207
    v_cvt_pk_bf16_f32 v216, v192, v193
    v_cvt_pk_bf16_f32 v217, v194, v195
    v_cvt_pk_bf16_f32 v218, v196, v197
    v_cvt_pk_bf16_f32 v219, v198, v199
    v_cvt_pk_bf16_f32 v220, v200, v201
    v_cvt_pk_bf16_f32 v221, v202, v203
    v_cvt_pk_bf16_f32 v222, v204, v205
    v_cvt_pk_bf16_f32 v223, v206, v207
    v_mfma_f32_32x32x16_bf16 v[192:207], v[64:67], v[152:155], 0
    v_exp_f32 v176, v176
    v_exp_f32 v177, v177
    v_exp_f32 v178, v178
    v_exp_f32 v179, v179
    v_mfma_f32_32x32x16_bf16 v[128:143], v[56:59], v[216:219], v[128:143]
    v_exp_f32 v180, v180
    v_exp_f32 v181, v181
    v_exp_f32 v182, v182
    v_exp_f32 v183, v183
    v_mfma_f32_32x32x16_bf16 v[192:207], v[68:71], v[156:159], v[192:207]
    v_exp_f32 v184, v184
    v_exp_f32 v185, v185
    v_exp_f32 v186, v186
    v_exp_f32 v187, v187
    v_mfma_f32_32x32x16_bf16 v[128:143], v[60:63], v[220:223], v[128:143]
    s_cmp_ge_u32 s3, 4
    s_cbranch_scc1 k2_nohl
    s_mul_i32 s8, s6, 16*1792
    buffer_load_dword v224, v251, s[72:75], s8 offen
    s_add_u32 s8, s8, 1792
    buffer_load_dword v225, v251, s[72:75], s8 offen
    s_add_u32 s8, s8, 1792
    buffer_load_dword v226, v251, s[72:75], s8 offen
    s_add_u32 s8, s8, 1792
    buffer_load_dword v227, v251, s[72:75], s8 offen
    s_add_u32 s8, s8, 1792
    buffer_load_dword v228, v251, s[72:75], s8 offen
    s_add_u32 s8, s8, 1792
    buffer_load_dword v229, v251, s[72:75], s8 offen
    s_add_u32 s8, s8, 1792
    buffer_load_dword v230, v251, s[72:75], s8 offen
    s_add_u32 s8, s8, 1792
    buffer_load_dword v231, v251, s[72:75], s8 offen
    s_add_u32 s8, s8, 1792
    buffer_load_dword v232, v251, s[72:75], s8 offen
    s_add_u32 s8, s8, 1792
    buffer_load_dword v233, v251, s[72:75], s8 offen
    s_add_u32 s8, s8, 1792
    buffer_load_dword v234, v251, s[72:75], s8 offen
    s_add_u32 s8, s8, 1792
    buffer_load_dword v235, v251, s[72:75], s8 offen
    s_add_u32 s8, s8, 1792
    buffer_load_dword v236, v251, s[72:75], s8 offen
    s_add_u32 s8, s8, 1792
    buffer_load_dword v237, v251, s[72:75], s8 offen
    s_add_u32 s8, s8, 1792
    buffer_load_dword v238, v251, s[72:75], s8 offen
    s_add_u32 s8, s8, 1792
    buffer_load_dword v239, v251, s[72:75], s8 offen
    s_add_u32 s8, s8, 1792
    s_cmp_eq_u32 s3, 0
    s_cselect_b32 s60, s26, s28
    s_cselect_b32 s61, s27, s29
    s_cmp_ge_u32 s3, 2
    s_cselect_b32 s60, s38, s60
    s_cselect_b32 s61, s39, s61
    s_mov_b32 s62, 401408
    s_mov_b32 s63, 0x20000
    s_mov_b32 s10, 13
    s_cmp_eq_u32 s3, 3
    s_cselect_b32 s60, s16, s60
    s_cselect_b32 s61, s17, s61
    s_cselect_b32 s62, 1835008, s62
    s_cselect_b32 s10, 56, s10
    s_mul_i32 s8, s2, s10
    v_add_u32 v252, s8, v0
    v_lshlrev_b32 v252, 7, v252
    v_cmp_gt_u32 vcc, s10, v0
    v_mov_b32 v253, 0x7fffff00
    s_nop 0
    v_cndmask_b32 v252, v253, v252, vcc
    buffer_load_dword v252, v252, s[60:63], 0 offen
k2_nohl:
    v_exp_f32 v188, v188
    v_exp_f32 v189, v189
    v_exp_f32 v190, v190
    v_exp_f32 v191, v191
    v_cvt_pk_bf16_f32 v208, v176, v177
    v_cvt_pk_bf16_f32 v209, v178, v179
    v_cvt_pk_bf16_f32 v210, v180, v181
    v_cvt_pk_bf16_f32 v211, v182, v183
    v_cvt_pk_bf16_f32 v212, v184, v185
    v_cvt_pk_bf16_f32 v213, v186, v187
    v_cvt_pk_bf16_f32 v214, v188, v189
    v_cvt_pk_bf16_f32 v215, v190, v191
    v_mfma_f32_32x32x16_bf16 v[176:191], v[64:67], v[160:163], 0
    v_exp_f32 v192, v192
    v_exp_f32 v193, v193
    v_exp_f32 v194, v194
    v_exp_f32 v195, v195
    v_mfma_f32_32x32x16_bf16 v[80:95], v[72:75], v[208:211], v[80:95]
    v_exp_f32 v196, v196
    v_exp_f32 v197, v197
    v_exp_f32 v198, v198
    v_exp_f32 v199, v199
    v_mfma_f32_32x32x16_bf16 v[176:191], v[68:71], v[164:167], v[176:191]
    v_exp_f32 v200, v200
    v_exp_f32 v201, v201
    v_exp_f32 v202, v202
    v_exp_f32 v203, v203
    v_mfma_f32_32x32x16_bf16 v[80:95], v[76:79], v[212:215], v[80:95]
    v_exp_f32 v204, v204
    v_exp_f32 v205, v205
    v_exp_f32 v206, v206
    v_exp_f32 v207, v207
    v_cvt_pk_bf16_f32 v216, v192, v193
    v_cvt_pk_bf16_f32 v217, v194, v195
    v_cvt_pk_bf16_f32 v218, v196, v197
    v_cvt_pk_bf16_f32 v219, v198, v199
    v_cvt_pk_bf16_f32 v220, v200, v201
    v_cvt_pk_bf16_f32 v221, v202, v203
    v_cvt_pk_bf16_f32 v222, v204, v205
    v_cvt_pk_bf16_f32 v223, v206, v207
    v_mfma_f32_32x32x16_bf16 v[192:207], v[64:67], v[168:171], 0
    v_exp_f32 v176, v176
    v_exp_f32 v177, v177
    v_exp_f32 v178, v178
    v_exp_f32 v179, v179
    v_mfma_f32_32x32x16_bf16 v[96:111], v[72:75], v[216:219], v[96:111]
    v_exp_f32 v180, v180
    v_exp_f32 v181, v181
    v_exp_f32 v182, v182
    v_exp_f32 v183, v183
    v_mfma_f32_32x32x16_bf16 v[192:207], v[68:71], v[172:175], v[192:207]
    v_exp_f32 v184, v184
    v_exp_f32 v185, v185
    v_exp_f32 v186, v186
    v_exp_f32 v187, v187
    v_mfma_f32_32x32x16_bf16 v[96:111], v[76:79], v[220:223], v[96:111]
    v_exp_f32 v188, v188
    v_exp_f32 v189, v189
    v_exp_f32 v190, v190
    v_exp_f32 v191, v191
    v_cvt_pk_bf16_f32 v208, v176, v177
    v_cvt_pk_bf16_f32 v209, v178, v179
    v_cvt_pk_bf16_f32 v210, v180, v181
    v_cvt_pk_bf16_f32 v211, v182, v183
    v_cvt_pk_bf16_f32 v212, v184, v185
    v_cvt_pk_bf16_f32 v213, v186, v187
    v_cvt_pk_bf16_f32 v214, v188, v189
    v_cvt_pk_bf16_f32 v215, v190, v191
    v_exp_f32 v192, v192
    v_exp_f32 v193, v193
    v_exp_f32 v194, v194
    v_exp_f32 v195, v195
    v_mfma_f32_32x32x16_bf16 v[112:127], v[72:75], v[208:211], v[112:127]
    v_exp_f32 v196, v196
    v_exp_f32 v197, v197
    v_exp_f32 v198, v198
    v_exp_f32 v199, v199
    v_exp_f32 v200, v200
    v_exp_f32 v201, v201
    v_exp_f32 v202, v202
    v_exp_f32 v203, v203
    v_mfma_f32_32x32x16_bf16 v[112:127], v[76:79], v[212:215], v[112:127]
    v_exp_f32 v204, v204
    v_exp_f32 v205, v205
    v_exp_f32 v206, v206
    v_exp_f32 v207, v207
    v_cvt_pk_bf16_f32 v216, v192, v193
    v_cvt_pk_bf16_f32 v217, v194, v195
    v_cvt_pk_bf16_f32 v218, v196, v197
    v_cvt_pk_bf16_f32 v219, v198, v199
    v_cvt_pk_bf16_f32 v220, v200, v201
    v_cvt_pk_bf16_f32 v221, v202, v203
    v_cvt_pk_bf16_f32 v222, v204, v205
    v_cvt_pk_bf16_f32 v223, v206, v207
    s_nop 1
    v_mfma_f32_32x32x16_bf16 v[128:143], v[72:75], v[216:219], v[128:143]
    v_mfma_f32_32x32x16_bf16 v[128:143], v[76:79], v[220:223], v[128:143]
    s_nop 15
    s_lshl_b32 s8, s3, 14
    v_add_u32 v8, s8, v3
    ds_write_b128 v8, v[80:83] offset:0
    ds_write_b128 v8, v[84:87] offset:1024
    ds_write_b128 v8, v[88:91] offset:2048
    ds_write_b128 v8, v[92:95] offset:3072
    ds_write_b128 v8, v[96:99] offset:4096
    ds_write_b128 v8, v[100:103] offset:5120
    ds_write_b128 v8, v[104:107] offset:6144
    ds_write_b128 v8, v[108:111] offset:7168
    ds_write_b128 v8, v[112:115] offset:8192
    ds_write_b128 v8, v[116:119] offset:9216
    ds_write_b128 v8, v[120:123] offset:10240
    ds_write_b128 v8, v[124:127] offset:11264
    ds_write_b128 v8, v[128:131] offset:12288
    ds_write_b128 v8, v[132:135] offset:13312
    ds_write_b128 v8, v[136:139] offset:14336
    ds_write_b128 v8, v[140:143] offset:15360
    s_cmp_ge_u32 s3, 4
    s_cbranch_scc1 k2_noside3
    s_mul_i32 s8, s6, 16*1792
    s_add_u32 s10, s8, 896
    s_waitcnt vmcnt(0)
    v_mov_b32 v244, v242
    v_mov_b32 v245, v243
    v_pk_mul_f32 v[246:247], v[240:241], v[244:245] op_sel:[0,0] op_sel_hi:[0,1]
    v_pk_fma_f32 v[246:247], v[240:241], v[244:245], v[246:247] op_sel:[1,1,0] op_sel_hi:[1,0,1] neg_lo:[1,0,0]
    v_lshlrev_b32 v248, 16, v224
    v_and_b32 v249, 0xffff0000, v224
    v_pk_add_f32 v[248:249], v[248:249], v[246:247]
    v_cvt_pk_bf16_f32 v224, v248, -v249
    buffer_store_short v224, v250, s[84:87], s8 offen
    buffer_store_short_d16_hi v224, v250, s[84:87], s10 offen
    s_add_u32 s8, s8, 1792
    s_add_u32 s10, s10, 1792
    v_pk_mul_f32 v[244:245], v[240:241], v[246:247] op_sel:[0,0] op_sel_hi:[0,1]
    v_pk_fma_f32 v[244:245], v[240:241], v[246:247], v[244:245] op_sel:[1,1,0] op_sel_hi:[1,0,1] neg_lo:[1,0,0]
    v_lshlrev_b32 v248, 16, v225
    v_and_b32 v249, 0xffff0000, v225
    v_pk_add_f32 v[248:249], v[248:249], v[244:245]
    v_cvt_pk_bf16_f32 v225, v248, -v249
    buffer_store_short v225, v250, s[84:87], s8 offen
    buffer_store_short_d16_hi v225, v250, s[84:87], s10 offen
    s_add_u32 s8, s8, 1792
    s_add_u32 s10, s10, 1792
    v_pk_mul_f32 v[246:247], v[240:241], v[244:245] op_sel:[0,0] op_sel_hi:[0,1]
    v_pk_fma_f32 v[246:247], v[240:241], v[244:245], v[246:247] op_sel:[1,1,0] op_sel_hi:[1,0,1] neg_lo:[1,0,0]
    v_lshlrev_b32 v248, 16, v226
    v_and_b32 v249, 0xffff0000, v226
    v_pk_add_f32 v[248:249], v[248:249], v[246:247]
    v_cvt_pk_bf16_f32 v226, v248, -v249
    buffer_store_short v226, v250, s[84:87], s8 offen
    buffer_store_short_d16_hi v226, v250, s[84:87], s10 offen
    s_add_u32 s8, s8, 1792
    s_add_u32 s10, s10, 1792
    v_pk_mul_f32 v[244:245], v[240:241], v[246:247] op_sel:[0,0] op_sel_hi:[0,1]
    v_pk_fma_f32 v[244:245], v[240:241], v[246:247], v[244:245] op_sel:[1,1,0] op_sel_hi:[1,0,1] neg_lo:[1,0,0]
    v_lshlrev_b32 v248, 16, v227
    v_and_b32 v249, 0xffff0000, v227
    v_pk_add_f32 v[248:249], v[248:249], v[244:245]
    v_cvt_pk_bf16_f32 v227, v248, -v249
    buffer_store_short v227, v250, s[84:87], s8 offen
    buffer_store_short_d16_hi v227, v250, s[84:87], s10 offen
    s_add_u32 s8, s8, 1792
    s_add_u32 s10, s10, 1792
    v_pk_mul_f32 v[246:247], v[240:241], v[244:245] op_sel:[0,0] op_sel_hi:[0,1]
    v_pk_fma_f32 v[246:247], v[240:241], v[244:245], v[246:247] op_sel:[1,1,0] op_sel_hi:[1,0,1] neg_lo:[1,0,0]
    v_lshlrev_b32 v248, 16, v228
    v_and_b32 v249, 0xffff0000, v228
    v_pk_add_f32 v[248:249], v[248:249], v[246:247]
    v_cvt_pk_bf16_f32 v228, v248, -v249
    buffer_store_short v228, v250, s[84:87], s8 offen
    buffer_store_short_d16_hi v228, v250, s[84:87], s10 offen
    s_add_u32 s8, s8, 1792
    s_add_u32 s10, s10, 1792
    v_pk_mul_f32 v[244:245], v[240:241], v[246:247] op_sel:[0,0] op_sel_hi:[0,1]
    v_pk_fma_f32 v[244:245], v[240:241], v[246:247], v[244:245] op_sel:[1,1,0] op_sel_hi:[1,0,1] neg_lo:[1,0,0]
    v_lshlrev_b32 v248, 16, v229
    v_and_b32 v249, 0xffff0000, v229
    v_pk_add_f32 v[248:249], v[248:249], v[244:245]
    v_cvt_pk_bf16_f32 v229, v248, -v249
    buffer_store_short v229, v250, s[84:87], s8 offen
    buffer_store_short_d16_hi v229, v250, s[84:87], s10 offen
    s_add_u32 s8, s8, 1792
    s_add_u32 s10, s10, 1792
    v_pk_mul_f32 v[246:247], v[240:241], v[244:245] op_sel:[0,0] op_sel_hi:[0,1]
    v_pk_fma_f32 v[246:247], v[240:241], v[244:245], v[246:247] op_sel:[1,1,0] op_sel_hi:[1,0,1] neg_lo:[1,0,0]
    v_lshlrev_b32 v248, 16, v230
    v_and_b32 v249, 0xffff0000, v230
    v_pk_add_f32 v[248:249], v[248:249], v[246:247]
    v_cvt_pk_bf16_f32 v230, v248, -v249
    buffer_store_short v230, v250, s[84:87], s8 offen
    buffer_store_short_d16_hi v230, v250, s[84:87], s10 offen
    s_add_u32 s8, s8, 1792
    s_add_u32 s10, s10, 1792
    v_pk_mul_f32 v[244:245], v[240:241], v[246:247] op_sel:[0,0] op_sel_hi:[0,1]
    v_pk_fma_f32 v[244:245], v[240:241], v[246:247], v[244:245] op_sel:[1,1,0] op_sel_hi:[1,0,1] neg_lo:[1,0,0]
    v_lshlrev_b32 v248, 16, v231
    v_and_b32 v249, 0xffff0000, v231
    v_pk_add_f32 v[248:249], v[248:249], v[244:245]
    v_cvt_pk_bf16_f32 v231, v248, -v249
    buffer_store_short v231, v250, s[84:87], s8 offen
    buffer_store_short_d16_hi v231, v250, s[84:87], s10 offen
    s_add_u32 s8, s8, 1792
    s_add_u32 s10, s10, 1792
    v_pk_mul_f32 v[246:247], v[240:241], v[244:245] op_sel:[0,0] op_sel_hi:[0,1]
    v_pk_fma_f32 v[246:247], v[240:241], v[244:245], v[246:247] op_sel:[1,1,0] op_sel_hi:[1,0,1] neg_lo:[1,0,0]
    v_lshlrev_b32 v248, 16, v232
    v_and_b32 v249, 0xffff0000, v232
    v_pk_add_f32 v[248:249], v[248:249], v[246:247]
    v_cvt_pk_bf16_f32 v232, v248, -v249
    buffer_store_short v232, v250, s[84:87], s8 offen
    buffer_store_short_d16_hi v232, v250, s[84:87], s10 offen
    s_add_u32 s8, s8, 1792
    s_add_u32 s10, s10, 1792
    v_pk_mul_f32 v[244:245], v[240:241], v[246:247] op_sel:[0,0] op_sel_hi:[0,1]
    v_pk_fma_f32 v[244:245], v[240:241], v[246:247], v[244:245] op_sel:[1,1,0] op_sel_hi:[1,0,1] neg_lo:[1,0,0]
    v_lshlrev_b32 v248, 16, v233
    v_and_b32 v249, 0xffff0000, v233
    v_pk_add_f32 v[248:249], v[248:249], v[244:245]
    v_cvt_pk_bf16_f32 v233, v248, -v249
    buffer_store_short v233, v250, s[84:87], s8 offen
    buffer_store_short_d16_hi v233, v250, s[84:87], s10 offen
    s_add_u32 s8, s8, 1792
    s_add_u32 s10, s10, 1792
    v_pk_mul_f32 v[246:247], v[240:241], v[244:245] op_sel:[0,0] op_sel_hi:[0,1]
    v_pk_fma_f32 v[246:247], v[240:241], v[244:245], v[246:247] op_sel:[1,1,0] op_sel_hi:[1,0,1] neg_lo:[1,0,0]
    v_lshlrev_b32 v248, 16, v234
    v_and_b32 v249, 0xffff0000, v234
    v_pk_add_f32 v[248:249], v[248:249], v[246:247]
    v_cvt_pk_bf16_f32 v234, v248, -v249
    buffer_store_short v234, v250, s[84:87], s8 offen
    buffer_store_short_d16_hi v234, v250, s[84:87], s10 offen
    s_add_u32 s8, s8, 1792
    s_add_u32 s10, s10, 1792
    v_pk_mul_f32 v[244:245], v[240:241], v[246:247] op_sel:[0,0] op_sel_hi:[0,1]
    v_pk_fma_f32 v[244:245], v[240:241], v[246:247], v[244:245] op_sel:[1,1,0] op_sel_hi:[1,0,1] neg_lo:[1,0,0]
    v_lshlrev_b32 v248, 16, v235
    v_and_b32 v249, 0xffff0000, v235
    v_pk_add_f32 v[248:249], v[248:249], v[244:245]
    v_cvt_pk_bf16_f32 v235, v248, -v249
    buffer_store_short v235, v250, s[84:87], s8 offen
    buffer_store_short_d16_hi v235, v250, s[84:87], s10 offen
    s_add_u32 s8, s8, 1792
    s_add_u32 s10, s10, 1792
    v_pk_mul_f32 v[246:247], v[240:241], v[244:245] op_sel:[0,0] op_sel_hi:[0,1]
    v_pk_fma_f32 v[246:247], v[240:241], v[244:245], v[246:247] op_sel:[1,1,0] op_sel_hi:[1,0,1] neg_lo:[1,0,0]
    v_lshlrev_b32 v248, 16, v236
    v_and_b32 v249, 0xffff0000, v236
    v_pk_add_f32 v[248:249], v[248:249], v[246:247]
    v_cvt_pk_bf16_f32 v236, v248, -v249
    buffer_store_short v236, v250, s[84:87], s8 offen
    buffer_store_short_d16_hi v236, v250, s[84:87], s10 offen
    s_add_u32 s8, s8, 1792
    s_add_u32 s10, s10, 1792
    v_pk_mul_f32 v[244:245], v[240:241], v[246:247] op_sel:[0,0] op_sel_hi:[0,1]
    v_pk_fma_f32 v[244:245], v[240:241], v[246:247], v[244:245] op_sel:[1,1,0] op_sel_hi:[1,0,1] neg_lo:[1,0,0]
    v_lshlrev_b32 v248, 16, v237
    v_and_b32 v249, 0xffff0000, v237
    v_pk_add_f32 v[248:249], v[248:249], v[244:245]
    v_cvt_pk_bf16_f32 v237, v248, -v249
    buffer_store_short v237, v250, s[84:87], s8 offen
    buffer_store_short_d16_hi v237, v250, s[84:87], s10 offen
    s_add_u32 s8, s8, 1792
    s_add_u32 s10, s10, 1792
    v_pk_mul_f32 v[246:247], v[240:241], v[244:245] op_sel:[0,0] op_sel_hi:[0,1]
    v_pk_fma_f32 v[246:247], v[240:241], v[244:245], v[246:247] op_sel:[1,1,0] op_sel_hi:[1,0,1] neg_lo:[1,0,0]
    v_lshlrev_b32 v248, 16, v238
    v_and_b32 v249, 0xffff0000, v238
    v_pk_add_f32 v[248:249], v[248:249], v[246:247]
    v_cvt_pk_bf16_f32 v238, v248, -v249
    buffer_store_short v238, v250, s[84:87], s8 offen
    buffer_store_short_d16_hi v238, v250, s[84:87], s10 offen
    s_add_u32 s8, s8, 1792
    s_add_u32 s10, s10, 1792
    v_pk_mul_f32 v[244:245], v[240:241], v[246:247] op_sel:[0,0] op_sel_hi:[0,1]
    v_pk_fma_f32 v[244:245], v[240:241], v[246:247], v[244:245] op_sel:[1,1,0] op_sel_hi:[1,0,1] neg_lo:[1,0,0]
    v_lshlrev_b32 v248, 16, v239
    v_and_b32 v249, 0xffff0000, v239
    v_pk_add_f32 v[248:249], v[248:249], v[244:245]
    v_cvt_pk_bf16_f32 v239, v248, -v249
    buffer_store_short v239, v250, s[84:87], s8 offen
    buffer_store_short_d16_hi v239, v250, s[84:87], s10 offen
    s_add_u32 s8, s8, 1792
    s_add_u32 s10, s10, 1792
k2_noside3:
    s_lshr_b32 s8, s3, 1
    s_lshl_b32 s9, s8, 12
    s_and_b32 s10, s3, 1
    s_lshl_b32 s12, s10, 11
    s_add_u32 s12, s12, s9
    v_add_u32 v8, s12, v3
    v_lshlrev_b32 v9, 4, v1
    s_add_u32 s9, s9, 3584
    v_add_u32 v9, s9, v9
    v_add_u32 v10, 0x10000, v8
    v_add_u32 v11, 0x10000, v9
    s_waitcnt lgkmcnt(0)
    s_barrier
    ds_read_b128 v[16:19], v8 offset:0
    ds_read_b128 v[20:23], v8 offset:1024
    ds_read_b32 v96, v9 offset:0
    ds_read_b128 v[24:27], v8 offset:16384
    ds_read_b128 v[28:31], v8 offset:17408
    ds_read_b32 v97, v9 offset:16384
    ds_read_b128 v[32:35], v8 offset:32768
    ds_read_b128 v[36:39], v8 offset:33792
    ds_read_b32 v98, v9 offset:32768
    ds_read_b128 v[40:43], v8 offset:49152
    ds_read_b128 v[44:47], v8 offset:50176
    ds_read_b32 v99, v9 offset:49152
    s_waitcnt lgkmcnt(0)
    ds_read_b128 v[48:51], v10 offset:0
    ds_read_b128 v[52:55], v10 offset:1024
    ds_read_b32 v100, v11 offset:0
    ds_read_b128 v[56:59], v10 offset:16384
    ds_read_b128 v[60:63], v10 offset:17408
    ds_read_b32 v101, v11 offset:16384
    ds_read_b128 v[64:67], v10 offset:32768
    ds_read_b128 v[68:71], v10 offset:33792
    ds_read_b32 v102, v11 offset:32768
    ds_read_b128 v[72:75], v10 offset:49152
    ds_read_b128 v[76:79], v10 offset:50176
    ds_read_b32 v103, v11 offset:49152
    s_waitcnt lgkmcnt(0)
    v_pk_add_f32 v[16:17], v[16:17], v[24:25]
    v_pk_add_f32 v[18:19], v[18:19], v[26:27]
    v_pk_add_f32 v[20:21], v[20:21], v[28:29]
    v_pk_add_f32 v[22:23], v[22:23], v[30:31]
    v_add_f32 v96, v96, v97
    v_pk_add_f32 v[16:17], v[16:17], v[32:33]
    v_pk_add_f32 v[18:19], v[18:19], v[34:35]
    v_pk_add_f32 v[20:21], v[20:21], v[36:37]
    v_pk_add_f32 v[22:23], v[22:23], v[38:39]
    v_add_f32 v96, v96, v98
    v_pk_add_f32 v[16:17], v[16:17], v[40:41]
    v_pk_add_f32 v[18:19], v[18:19], v[42:43]
    v_pk_add_f32 v[20:21], v[20:21], v[44:45]
    v_pk_add_f32 v[22:23], v[22:23], v[46:47]
    v_add_f32 v96, v96, v99
    v_pk_add_f32 v[16:17], v[16:17], v[48:49]
    v_pk_add_f32 v[18:19], v[18:19], v[50:51]
    v_pk_add_f32 v[20:21], v[20:21], v[52:53]
    v_pk_add_f32 v[22:23], v[22:23], v[54:55]
    v_add_f32 v96, v96, v100
    v_pk_add_f32 v[16:17], v[16:17], v[56:57]
    v_pk_add_f32 v[18:19], v[18:19], v[58:59]
    v_pk_add_f32 v[20:21], v[20:21], v[60:61]
    v_pk_add_f32 v[22:23], v[22:23], v[62:63]
    v_add_f32 v96, v96, v101
    v_pk_add_f32 v[16:17], v[16:17], v[64:65]
    v_pk_add_f32 v[18:19], v[18:19], v[66:67]
    v_pk_add_f32 v[20:21], v[20:21], v[68:69]
    v_pk_add_f32 v[22:23], v[22:23], v[70:71]
    v_add_f32 v96, v96, v102
    v_pk_add_f32 v[16:17], v[16:17], v[72:73]
    v_pk_add_f32 v[18:19], v[18:19], v[74:75]
    v_pk_add_f32 v[20:21], v[20:21], v[76:77]
    v_pk_add_f32 v[22:23], v[22:23], v[78:79]
    v_add_f32 v96, v96, v103
    v_cmp_ngt_f32 vcc, 0x4e800000, v96
    s_nop 1
    s_cmp_lg_u64 vcc, 0
    s_cselect_b32 s94, 1, 0
    v_mov_b32 v12, s94
    v_mov_b32 v13, 0x20000
    s_lshl_b32 s8, s3, 2
    v_add_u32 v13, s8, v13
    ds_write_b32 v13, v12
    v_mov_b32 v13, 0x20000
    s_waitcnt lgkmcnt(0)
    s_barrier
    ds_read_b128 v[104:107], v13
    ds_read_b128 v[108:111], v13 offset:16
    s_waitcnt lgkmcnt(0)
    v_or3_b32 v104, v104, v105, v106
    v_or3_b32 v104, v104, v107, v108
    v_or3_b32 v104, v104, v109, v110
    v_or_b32 v104, v104, v111
    s_nop 0
    v_readfirstlane_b32 s94, v104
    s_cmp_eq_u32 s94, 0
    s_cbranch_scc1 k2_fin
    s_cmp_eq_u32 s91, 64
    s_cbranch_scc1 k2_fin
    s_mov_b32 s91, 64
    s_mov_b32 s90, s13
    s_add_u32 s15, s90, 0x200000
    buffer_load_dwordx4 v[16:19], v3, s[48:51], s90 offen
    buffer_load_dwordx4 v[20:23], v3, s[48:51], s90 offen offset:1024
    buffer_load_dwordx4 v[24:27], v3, s[48:51], s15 offen
    buffer_load_dwordx4 v[28:31], v3, s[48:51], s15 offen offset:1024
    s_add_u32 s90, s90, 2048
    s_add_u32 s15, s90, 0x200000
    buffer_load_dwordx4 v[32:35], v3, s[48:51], s90 offen
    buffer_load_dwordx4 v[36:39], v3, s[48:51], s90 offen offset:1024
    buffer_load_dwordx4 v[40:43], v3, s[48:51], s15 offen
    buffer_load_dwordx4 v[44:47], v3, s[48:51], s15 offen offset:1024
    s_add_u32 s90, s90, 2048
    s_waitcnt vmcnt(0)
    s_branch k2_restart
k2_fin:
    v_rcp_f32 v96, v96
    s_nop 0
    v_mul_f32 v16, v16, v96
    v_mul_f32 v17, v17, v96
    v_mul_f32 v18, v18, v96
    v_mul_f32 v19, v19, v96
    v_mul_f32 v20, v20, v96
    v_mul_f32 v21, v21, v96
    v_mul_f32 v22, v22, v96
    v_mul_f32 v23, v23, v96
    v_cvt_pk_bf16_f32 v16, v16, v17
    v_cvt_pk_bf16_f32 v17, v18, v19
    v_cvt_pk_bf16_f32 v18, v20, v21
    v_cvt_pk_bf16_f32 v19, v22, v23
    s_lshl_b32 s8, s5, 7
    s_lshr_b32 s9, s3, 1
    s_lshl_b32 s9, s9, 5
    s_add_u32 s8, s8, s9
    v_add_u32 v8, s8, v1
    v_mul_u32_u24 v8, 896, v8
    s_mul_i32 s9, s4, 56
    s_and_b32 s10, s3, 1
    s_lshl_b32 s12, s10, 5
    s_add_u32 s9, s9, s12
    v_lshl_add_u32 v8, v2, 3, v8
    v_add_u32 v8, s9, v8
    buffer_store_dwordx2 v[16:17], v8, s[56:59], 0 offen
    s_cmp_eq_u32 s10, 0
    s_cbranch_scc1 k2_st2
    s_mov_b32 exec_hi, 0
k2_st2:
    buffer_store_dwordx2 v[18:19], v8, s[56:59], 0 offen offset:16
k2_exit:
    s_endpgm
.globl k3_kernel
.p2align 8
.type k3_kernel,@function
k3_kernel:
    s_cmp_ge_u32 s2, 224
    s_cbranch_scc1 k3_exit
    s_load_dwordx16 s[16:31], s[0:1], 0
    s_load_dwordx8 s[32:39], s[0:1], 64
    s_load_dwordx2 s[40:41], s[0:1], 96
    s_load_dwordx2 s[42:43], s[0:1], 112
    v_lshrrev_b32 v1, 6, v0
    v_and_b32 v0, 63, v0
    s_nop 0
    v_readfirstlane_b32 s3, v1
    s_and_b32 s4, s2, 7
    s_lshr_b32 s5, s2, 3
    s_and_b32 s6, s5, 1
    s_lshl_b32 s8, s4, 1
    s_add_u32 s6, s6, s8
    s_lshr_b32 s7, s5, 1
    s_and_b32 s9, s3, 3
    s_lshr_b32 s10, s3, 2

    v_and_b32 v1, 31, v0
    v_lshrrev_b32 v2, 5, v0
    v_lshrrev_b32 v3, 3, v0
    v_and_b32 v4, 7, v0
    v_lshrrev_b32 v5, 4, v0
    s_lshl_b32 s11, s9, 5
    v_add_u32 v6, s11, v1
    v_lshrrev_b32 v7, 1, v1
    v_and_b32 v7, 7, v7
    v_xor_b32 v7, v7, v2
    v_lshlrev_b32 v7, 4, v7
    v_lshl_add_u32 v8, v6, 7, v7
    v_xor_b32 v9, 32, v8
    v_xor_b32 v10, 64, v8
    v_xor_b32 v11, 0x60, v8
    v_add_u32 v24, 0x10000, v8
    v_add_u32 v25, 0x10000, v9
    v_add_u32 v26, 0x10000, v10
    v_add_u32 v27, 0x10000, v11
    v_xor_b32 v12, v4, v5
    v_lshlrev_b32 v12, 4, v12
    v_xor_b32 v13, 64, v12

    s_lshl_b32 s74, s3, 11
    s_lshl_b32 s75, s3, 10
    s_add_u32 s75, s75, 98304
    s_lshl_b32 s11, s6, 7
    s_lshl_b32 s12, s3, 4
    s_add_u32 s11, s11, s12
    v_add_u32 v22, s11, v3
    s_waitcnt lgkmcnt(0)
    s_mov_b32 s56, s40
    s_mov_b32 s57, s41
    s_mov_b32 s58, 0x700000
    s_mov_b32 s59, 0x20000
    s_lshl_b32 s11, s6, 7
    s_lshl_b32 s12, s9, 5
    s_add_u32 s11, s11, s12
    v_add_u32 v23, s11, v1
    s_cmp_ge_u32 s7, 7
    s_cbranch_scc1 k3_o
    s_add_u32 s44, s42, 0xe00000
    s_addc_u32 s45, s43, 0
    s_mov_b32 s46, 0x380000
    s_mov_b32 s47, 0x20000
    s_mov_b32 s48, s26
    s_mov_b32 s49, s27
    s_mov_b32 s50, 0x62000
    s_mov_b32 s51, 0x20000
    s_mov_b32 s52, s28
    s_mov_b32 s53, s29
    s_mov_b32 s54, 0x62000
    s_mov_b32 s55, 0x20000
    s_mov_b32 s60, s16
    s_mov_b32 s61, s17
    s_mov_b32 s62, 0x1c0000
    s_mov_b32 s63, 0x20000
    s_mov_b32 s64, s32
    s_mov_b32 s65, s33
    s_mov_b32 s66, 0x380
    s_mov_b32 s67, 0x20000
    v_mul_u32_u24 v6, 1792, v22
    v_add_u32 v14, v6, v12
    v_add_u32 v15, v6, v13
    v_add_u32 v15, 14336, v15
    s_lshl_b32 s11, s7, 6
    s_lshl_b32 s13, s3, 3
    s_add_u32 s13, s13, s11
    v_add_u32 v6, s13, v3
    v_mul_u32_u24 v6, 896, v6
    s_and_b32 s14, s3, 1
    s_lshl_b32 s14, s14, 6
    v_xor_b32 v7, s14, v12
    v_add_u32 v16, v6, v7
    s_lshl_b32 s13, s10, 12
    s_add_u32 s13, s13, 98304
    v_lshrrev_b32 v7, 1, v1
    v_and_b32 v7, 7, v7
    v_xor_b32 v7, v7, v2
    v_lshlrev_b32 v7, 4, v7
    v_lshl_add_u32 v18, v1, 7, v7
    v_add_u32 v18, s13, v18
    v_xor_b32 v19, 32, v18
    v_xor_b32 v20, 64, v18
    v_xor_b32 v21, 0x60, v18
    s_lshl_b32 s12, s10, 5
    s_add_u32 s12, s12, s11
    s_lshl_b32 s15, s12, 1
    v_mul_u32_u24 v6, 896, v23
    v_lshl_add_u32 v6, v2, 3, v6
    v_lshlrev_b32 v7, 3, v2
    buffer_load_dwordx2 v[64:65], v6, s[60:63], s15 offen offset:0
    buffer_load_dwordx2 v[72:73], v7, s[64:67], s15 offen offset:0
    buffer_load_dwordx2 v[66:67], v6, s[60:63], s15 offen offset:16
    buffer_load_dwordx2 v[74:75], v7, s[64:67], s15 offen offset:16
    buffer_load_dwordx2 v[68:69], v6, s[60:63], s15 offen offset:32
    buffer_load_dwordx2 v[76:77], v7, s[64:67], s15 offen offset:32
    buffer_load_dwordx2 v[70:71], v6, s[60:63], s15 offen offset:48
    buffer_load_dwordx2 v[78:79], v7, s[64:67], s15 offen offset:48
    s_add_u32 m0, s74, 0
    s_mov_b32 s76, 0
    buffer_load_dwordx4 v14, s[44:47], s76 offen lds
    s_add_u32 m0, s74, 1024
    s_mov_b32 s76, 0
    buffer_load_dwordx4 v15, s[44:47], s76 offen lds
    s_add_u32 m0, s75, 0
    s_mov_b32 s76, 0
    buffer_load_dwordx4 v16, s[48:51], s76 offen lds
    s_add_u32 m0, s74, 16384
    s_mov_b32 s76, 128
    buffer_load_dwordx4 v14, s[44:47], s76 offen lds
    s_add_u32 m0, s74, 17408
    s_mov_b32 s76, 128
    buffer_load_dwordx4 v15, s[44:47], s76 offen lds
    s_add_u32 m0, s75, 8192
    s_mov_b32 s76, 128
    buffer_load_dwordx4 v16, s[48:51], s76 offen lds
    s_add_u32 m0, s74, 32768
    s_mov_b32 s76, 256
    buffer_load_dwordx4 v14, s[44:47], s76 offen lds
    s_add_u32 m0, s74, 33792
    s_mov_b32 s76, 256
    buffer_load_dwordx4 v15, s[44:47], s76 offen lds
    s_add_u32 m0, s75, 16384
    s_mov_b32 s76, 256
    buffer_load_dwordx4 v16, s[48:51], s76 offen lds
    s_add_u32 m0, s74, 49152
    s_mov_b32 s76, 384
    buffer_load_dwordx4 v14, s[44:47], s76 offen lds
    s_add_u32 m0, s74, 50176
    s_mov_b32 s76, 384
    buffer_load_dwordx4 v15, s[44:47], s76 offen lds
    s_add_u32 m0, s75, 24576
    s_mov_b32 s76, 384
    buffer_load_dwordx4 v16, s[48:51], s76 offen lds
    s_add_u32 m0, s74, 65536
    s_mov_b32 s76, 512
    buffer_load_dwordx4 v14, s[44:47], s76 offen lds
    s_add_u32 m0, s74, 66560
    s_mov_b32 s76, 512
    buffer_load_dwordx4 v15, s[44:47], s76 offen lds
    s_add_u32 m0, s75, 32768
    s_mov_b32 s76, 512
    buffer_load_dwordx4 v16, s[48:51], s76 offen lds
    s_waitcnt vmcnt(12) lgkmcnt(0)
    s_barrier
    ds_read_b128 v[96:99], v8 offset:0
    ds_read_b128 v[100:103], v18 offset:0
    s_add_u32 m0, s74, 81920
    s_mov_b32 s76, 640
    buffer_load_dwordx4 v14, s[44:47], s76 offen lds
    ds_read_b128 v[104:107], v9 offset:0
    ds_read_b128 v[108:111], v19 offset:0
    s_add_u32 m0, s74, 82944
    s_mov_b32 s76, 640
    buffer_load_dwordx4 v15, s[44:47], s76 offen lds
    ds_read_b128 v[112:115], v10 offset:0
    ds_read_b128 v[116:119], v20 offset:0
    s_add_u32 m0, s75, 40960
    s_mov_b32 s76, 640
    buffer_load_dwordx4 v16, s[48:51], s76 offen lds
    ds_read_b128 v[120:123], v11 offset:0
    ds_read_b128 v[124:127], v21 offset:0
    s_waitcnt vmcnt(12) lgkmcnt(0)
    s_barrier
    ds_read_b128 v[128:131], v8 offset:16384
    ds_read_b128 v[132:135], v18 offset:8192
    v_mfma_f32_32x32x16_bf16 v[32:47], v[100:103], v[96:99], 0
    s_add_u32 m0, s74, 0
    s_mov_b32 s76, 768
    buffer_load_dwordx4 v14, s[44:47], s76 offen lds
    ds_read_b128 v[136:139], v9 offset:16384
    ds_read_b128 v[140:143], v19 offset:8192
    v_mfma_f32_32x32x16_bf16 v[32:47], v[108:111], v[104:107], v[32:47]
    s_add_u32 m0, s74, 1024
    s_mov_b32 s76, 768
    buffer_load_dwordx4 v15, s[44:47], s76 offen lds
    ds_read_b128 v[144:147], v10 offset:16384
    ds_read_b128 v[148:151], v20 offset:8192
    v_mfma_f32_32x32x16_bf16 v[32:47], v[116:119], v[112:115], v[32:47]
    s_add_u32 m0, s75, 0
    s_mov_b32 s76, 768
    buffer_load_dwordx4 v16, s[48:51], s76 offen lds
    ds_read_b128 v[152:155], v11 offset:16384
    ds_read_b128 v[156:159], v21 offset:8192
    v_mfma_f32_32x32x16_bf16 v[32:47], v[124:127], v[120:123], v[32:47]
    s_waitcnt vmcnt(12) lgkmcnt(0)
    s_barrier
    ds_read_b128 v[96:99], v8 offset:32768
    ds_read_b128 v[100:103], v18 offset:16384
    v_mfma_f32_32x32x16_bf16 v[32:47], v[132:135], v[128:131], v[32:47]
    s_add_u32 m0, s74, 16384
    s_mov_b32 s76, 896
    buffer_load_dwordx4 v14, s[44:47], s76 offen lds
    ds_read_b128 v[104:107], v9 offset:32768
    ds_read_b128 v[108:111], v19 offset:16384
    v_mfma_f32_32x32x16_bf16 v[32:47], v[140:143], v[136:139], v[32:47]
    s_add_u32 m0, s74, 17408
    s_mov_b32 s76, 896
    buffer_load_dwordx4 v15, s[44:47], s76 offen lds
    ds_read_b128 v[112:115], v10 offset:32768
    ds_read_b128 v[116:119], v20 offset:16384
    v_mfma_f32_32x32x16_bf16 v[32:47], v[148:151], v[144:147], v[32:47]
    s_add_u32 m0, s75, 8192
    s_mov_b32 s76, 0
    buffer_load_dwordx4 v16, s[52:55], s76 offen lds
    ds_read_b128 v[120:123], v11 offset:32768
    ds_read_b128 v[124:127], v21 offset:16384
    v_mfma_f32_32x32x16_bf16 v[32:47], v[156:159], v[152:155], v[32:47]
    s_waitcnt vmcnt(12) lgkmcnt(0)
    s_barrier
    ds_read_b128 v[128:131], v8 offset:49152
    ds_read_b128 v[132:135], v18 offset:24576
    v_mfma_f32_32x32x16_bf16 v[32:47], v[100:103], v[96:99], v[32:47]
    s_add_u32 m0, s74, 32768
    s_mov_b32 s76, 1024
    buffer_load_dwordx4 v14, s[44:47], s76 offen lds
    ds_read_b128 v[136:139], v9 offset:49152
    ds_read_b128 v[140:143], v19 offset:24576
    v_mfma_f32_32x32x16_bf16 v[32:47], v[108:111], v[104:107], v[32:47]
    s_add_u32 m0, s74, 33792
    s_mov_b32 s76, 1024
    buffer_load_dwordx4 v15, s[44:47], s76 offen lds
    ds_read_b128 v[144:147], v10 offset:49152
    ds_read_b128 v[148:151], v20 offset:24576
    v_mfma_f32_32x32x16_bf16 v[32:47], v[116:119], v[112:115], v[32:47]
    s_add_u32 m0, s75, 16384
    s_mov_b32 s76, 128
    buffer_load_dwordx4 v16, s[52:55], s76 offen lds
    ds_read_b128 v[152:155], v11 offset:49152
    ds_read_b128 v[156:159], v21 offset:24576
    v_mfma_f32_32x32x16_bf16 v[32:47], v[124:127], v[120:123], v[32:47]
    s_waitcnt vmcnt(12) lgkmcnt(0)
    s_barrier
    ds_read_b128 v[96:99], v24 offset:0
    ds_read_b128 v[100:103], v18 offset:32768
    v_mfma_f32_32x32x16_bf16 v[32:47], v[132:135], v[128:131], v[32:47]
    s_add_u32 m0, s74, 49152
    s_mov_b32 s76, 1152
    buffer_load_dwordx4 v14, s[44:47], s76 offen lds
    ds_read_b128 v[104:107], v25 offset:0
    ds_read_b128 v[108:111], v19 offset:32768
    v_mfma_f32_32x32x16_bf16 v[32:47], v[140:143], v[136:139], v[32:47]
    s_add_u32 m0, s74, 50176
    s_mov_b32 s76, 1152
    buffer_load_dwordx4 v15, s[44:47], s76 offen lds
    ds_read_b128 v[112:115], v26 offset:0
    ds_read_b128 v[116:119], v20 offset:32768
    v_mfma_f32_32x32x16_bf16 v[32:47], v[148:151], v[144:147], v[32:47]
    s_add_u32 m0, s75, 24576
    s_mov_b32 s76, 256
    buffer_load_dwordx4 v16, s[52:55], s76 offen lds
    ds_read_b128 v[120:123], v27 offset:0
    ds_read_b128 v[124:127], v21 offset:32768
    v_mfma_f32_32x32x16_bf16 v[32:47], v[156:159], v[152:155], v[32:47]
    s_waitcnt vmcnt(12) lgkmcnt(0)
    s_barrier
    ds_read_b128 v[128:131], v24 offset:16384
    ds_read_b128 v[132:135], v18 offset:40960
    v_mfma_f32_32x32x16_bf16 v[32:47], v[100:103], v[96:99], v[32:47]
    s_add_u32 m0, s74, 65536
    s_mov_b32 s76, 1280
    buffer_load_dwordx4 v14, s[44:47], s76 offen lds
    ds_read_b128 v[136:139], v25 offset:16384
    ds_read_b128 v[140:143], v19 offset:40960
    v_mfma_f32_32x32x16_bf16 v[32:47], v[108:111], v[104:107], v[32:47]
    s_add_u32 m0, s74, 66560
    s_mov_b32 s76, 1280
    buffer_load_dwordx4 v15, s[44:47], s76 offen lds
    ds_read_b128 v[144:147], v26 offset:16384
    ds_read_b128 v[148:151], v20 offset:40960
    v_mfma_f32_32x32x16_bf16 v[32:47], v[116:119], v[112:115], v[32:47]
    s_add_u32 m0, s75, 32768
    s_mov_b32 s76, 384
    buffer_load_dwordx4 v16, s[52:55], s76 offen lds
    ds_read_b128 v[152:155], v27 offset:16384
    ds_read_b128 v[156:159], v21 offset:40960
    v_mfma_f32_32x32x16_bf16 v[32:47], v[124:127], v[120:123], v[32:47]
    s_waitcnt vmcnt(12) lgkmcnt(0)
    s_barrier
    ds_read_b128 v[96:99], v8 offset:0
    ds_read_b128 v[100:103], v18 offset:0
    v_mfma_f32_32x32x16_bf16 v[32:47], v[132:135], v[128:131], v[32:47]
    s_add_u32 m0, s74, 81920
    s_mov_b32 s76, 1408
    buffer_load_dwordx4 v14, s[44:47], s76 offen lds
    ds_read_b128 v[104:107], v9 offset:0
    ds_read_b128 v[108:111], v19 offset:0
    v_mfma_f32_32x32x16_bf16 v[32:47], v[140:143], v[136:139], v[32:47]
    s_add_u32 m0, s74, 82944
    s_mov_b32 s76, 1408
    buffer_load_dwordx4 v15, s[44:47], s76 offen lds
    ds_read_b128 v[112:115], v10 offset:0
    ds_read_b128 v[116:119], v20 offset:0
    v_mfma_f32_32x32x16_bf16 v[32:47], v[148:151], v[144:147], v[32:47]
    s_add_u32 m0, s75, 40960
    s_mov_b32 s76, 512
    buffer_load_dwordx4 v16, s[52:55], s76 offen lds
    ds_read_b128 v[120:123], v11 offset:0
    ds_read_b128 v[124:127], v21 offset:0
    v_mfma_f32_32x32x16_bf16 v[32:47], v[156:159], v[152:155], v[32:47]
    s_waitcnt vmcnt(12) lgkmcnt(0)
    s_barrier
    ds_read_b128 v[128:131], v8 offset:16384
    ds_read_b128 v[132:135], v18 offset:8192
    v_mfma_f32_32x32x16_bf16 v[32:47], v[100:103], v[96:99], v[32:47]
    s_add_u32 m0, s74, 0
    s_mov_b32 s76, 1536
    buffer_load_dwordx4 v14, s[44:47], s76 offen lds
    ds_read_b128 v[136:139], v9 offset:16384
    ds_read_b128 v[140:143], v19 offset:8192
    v_mfma_f32_32x32x16_bf16 v[32:47], v[108:111], v[104:107], v[32:47]
    s_add_u32 m0, s74, 1024
    s_mov_b32 s76, 1536
    buffer_load_dwordx4 v15, s[44:47], s76 offen lds
    ds_read_b128 v[144:147], v10 offset:16384
    ds_read_b128 v[148:151], v20 offset:8192
    v_mfma_f32_32x32x16_bf16 v[32:47], v[116:119], v[112:115], v[32:47]
    s_add_u32 m0, s75, 0
    s_mov_b32 s76, 640
    buffer_load_dwordx4 v16, s[52:55], s76 offen lds
    ds_read_b128 v[152:155], v11 offset:16384
    ds_read_b128 v[156:159], v21 offset:8192
    v_mfma_f32_32x32x16_bf16 v[32:47], v[124:127], v[120:123], v[32:47]
    s_waitcnt vmcnt(12) lgkmcnt(0)
    s_barrier
    ds_read_b128 v[96:99], v8 offset:32768
    ds_read_b128 v[100:103], v18 offset:16384
    v_mfma_f32_32x32x16_bf16 v[32:47], v[132:135], v[128:131], v[32:47]
    s_add_u32 m0, s74, 16384
    s_mov_b32 s76, 1664
    buffer_load_dwordx4 v14, s[44:47], s76 offen lds
    ds_read_b128 v[104:107], v9 offset:32768
    ds_read_b128 v[108:111], v19 offset:16384
    v_mfma_f32_32x32x16_bf16 v[32:47], v[140:143], v[136:139], v[32:47]
    s_add_u32 m0, s74, 17408
    s_mov_b32 s76, 1664
    buffer_load_dwordx4 v15, s[44:47], s76 offen lds
    ds_read_b128 v[112:115], v10 offset:32768
    ds_read_b128 v[116:119], v20 offset:16384
    v_mfma_f32_32x32x16_bf16 v[32:47], v[148:151], v[144:147], v[32:47]
    s_add_u32 m0, s75, 8192
    s_mov_b32 s76, 768
    buffer_load_dwordx4 v16, s[52:55], s76 offen lds
    ds_read_b128 v[120:123], v11 offset:32768
    ds_read_b128 v[124:127], v21 offset:16384
    v_mfma_f32_32x32x16_bf16 v[32:47], v[156:159], v[152:155], v[32:47]
    s_waitcnt vmcnt(12) lgkmcnt(0)
    s_barrier
    ds_read_b128 v[128:131], v8 offset:49152
    ds_read_b128 v[132:135], v18 offset:24576
    v_mfma_f32_32x32x16_bf16 v[32:47], v[100:103], v[96:99], v[32:47]
    ds_read_b128 v[136:139], v9 offset:49152
    ds_read_b128 v[140:143], v19 offset:24576
    v_mfma_f32_32x32x16_bf16 v[32:47], v[108:111], v[104:107], v[32:47]
    ds_read_b128 v[144:147], v10 offset:49152
    ds_read_b128 v[148:151], v20 offset:24576
    v_mfma_f32_32x32x16_bf16 v[32:47], v[116:119], v[112:115], v[32:47]
    ds_read_b128 v[152:155], v11 offset:49152
    ds_read_b128 v[156:159], v21 offset:24576
    v_mfma_f32_32x32x16_bf16 v[32:47], v[124:127], v[120:123], v[32:47]
    s_waitcnt vmcnt(9) lgkmcnt(0)
    s_barrier
    ds_read_b128 v[96:99], v24 offset:0
    ds_read_b128 v[100:103], v18 offset:32768
    v_mfma_f32_32x32x16_bf16 v[32:47], v[132:135], v[128:131], v[32:47]
    ds_read_b128 v[104:107], v25 offset:0
    ds_read_b128 v[108:111], v19 offset:32768
    v_mfma_f32_32x32x16_bf16 v[32:47], v[140:143], v[136:139], v[32:47]
    ds_read_b128 v[112:115], v26 offset:0
    ds_read_b128 v[116:119], v20 offset:32768
    v_mfma_f32_32x32x16_bf16 v[32:47], v[148:151], v[144:147], v[32:47]
    ds_read_b128 v[120:123], v27 offset:0
    ds_read_b128 v[124:127], v21 offset:32768
    v_mfma_f32_32x32x16_bf16 v[32:47], v[156:159], v[152:155], v[32:47]
    s_waitcnt vmcnt(6) lgkmcnt(0)
    s_barrier
    ds_read_b128 v[128:131], v24 offset:16384
    ds_read_b128 v[132:135], v18 offset:40960
    v_mfma_f32_32x32x16_bf16 v[32:47], v[100:103], v[96:99], v[32:47]
    ds_read_b128 v[136:139], v25 offset:16384
    ds_read_b128 v[140:143], v19 offset:40960
    v_mfma_f32_32x32x16_bf16 v[32:47], v[108:111], v[104:107], v[32:47]
    ds_read_b128 v[144:147], v26 offset:16384
    ds_read_b128 v[148:151], v20 offset:40960
    v_mfma_f32_32x32x16_bf16 v[32:47], v[116:119], v[112:115], v[32:47]
    ds_read_b128 v[152:155], v27 offset:16384
    ds_read_b128 v[156:159], v21 offset:40960
    v_mfma_f32_32x32x16_bf16 v[32:47], v[124:127], v[120:123], v[32:47]
    s_waitcnt vmcnt(3) lgkmcnt(0)
    s_barrier
    ds_read_b128 v[96:99], v8 offset:0
    ds_read_b128 v[100:103], v18 offset:0
    v_mfma_f32_32x32x16_bf16 v[32:47], v[132:135], v[128:131], v[32:47]
    ds_read_b128 v[104:107], v9 offset:0
    ds_read_b128 v[108:111], v19 offset:0
    v_mfma_f32_32x32x16_bf16 v[32:47], v[140:143], v[136:139], v[32:47]
    ds_read_b128 v[112:115], v10 offset:0
    ds_read_b128 v[116:119], v20 offset:0
    v_mfma_f32_32x32x16_bf16 v[32:47], v[148:151], v[144:147], v[32:47]
    ds_read_b128 v[120:123], v11 offset:0
    ds_read_b128 v[124:127], v21 offset:0
    v_mfma_f32_32x32x16_bf16 v[32:47], v[156:159], v[152:155], v[32:47]
    s_waitcnt vmcnt(0) lgkmcnt(0)
    s_barrier
    ds_read_b128 v[128:131], v8 offset:16384
    ds_read_b128 v[132:135], v18 offset:8192
    v_mfma_f32_32x32x16_bf16 v[32:47], v[100:103], v[96:99], v[32:47]
    ds_read_b128 v[136:139], v9 offset:16384
    ds_read_b128 v[140:143], v19 offset:8192
    v_mfma_f32_32x32x16_bf16 v[32:47], v[108:111], v[104:107], v[32:47]
    ds_read_b128 v[144:147], v10 offset:16384
    ds_read_b128 v[148:151], v20 offset:8192
    v_mfma_f32_32x32x16_bf16 v[32:47], v[116:119], v[112:115], v[32:47]
    ds_read_b128 v[152:155], v11 offset:16384
    ds_read_b128 v[156:159], v21 offset:8192
    v_mfma_f32_32x32x16_bf16 v[32:47], v[124:127], v[120:123], v[32:47]
    s_waitcnt lgkmcnt(0)
    v_mfma_f32_32x32x16_bf16 v[32:47], v[132:135], v[128:131], v[32:47]
    v_mfma_f32_32x32x16_bf16 v[32:47], v[140:143], v[136:139], v[32:47]
    v_mfma_f32_32x32x16_bf16 v[32:47], v[148:151], v[144:147], v[32:47]
    v_mfma_f32_32x32x16_bf16 v[32:47], v[156:159], v[152:155], v[32:47]
    s_nop 7
    v_lshlrev_b32 v80, 16, v64
    v_lshlrev_b32 v17, 16, v72
    v_mul_f32 v80, v80, v17
    v_and_b32 v81, 0xffff0000, v64
    v_and_b32 v17, 0xffff0000, v72
    v_mul_f32 v81, v81, v17
    v_lshlrev_b32 v82, 16, v65
    v_lshlrev_b32 v17, 16, v73
    v_mul_f32 v82, v82, v17
    v_and_b32 v83, 0xffff0000, v65
    v_and_b32 v17, 0xffff0000, v73
    v_mul_f32 v83, v83, v17
    v_cvt_pk_bf16_f32 v17, v80, v81
    v_lshlrev_b32 v80, 16, v17
    v_and_b32 v81, 0xffff0000, v17
    v_cvt_pk_bf16_f32 v17, v82, v83
    v_lshlrev_b32 v82, 16, v17
    v_and_b32 v83, 0xffff0000, v17
    v_lshlrev_b32 v84, 16, v66
    v_lshlrev_b32 v17, 16, v74
    v_mul_f32 v84, v84, v17
    v_and_b32 v85, 0xffff0000, v66
    v_and_b32 v17, 0xffff0000, v74
    v_mul_f32 v85, v85, v17
    v_lshlrev_b32 v86, 16, v67
    v_lshlrev_b32 v17, 16, v75
    v_mul_f32 v86, v86, v17
    v_and_b32 v87, 0xffff0000, v67
    v_and_b32 v17, 0xffff0000, v75
    v_mul_f32 v87, v87, v17
    v_cvt_pk_bf16_f32 v17, v84, v85
    v_lshlrev_b32 v84, 16, v17
    v_and_b32 v85, 0xffff0000, v17
    v_cvt_pk_bf16_f32 v17, v86, v87
    v_lshlrev_b32 v86, 16, v17
    v_and_b32 v87, 0xffff0000, v17
    v_lshlrev_b32 v88, 16, v68
    v_lshlrev_b32 v17, 16, v76
    v_mul_f32 v88, v88, v17
    v_and_b32 v89, 0xffff0000, v68
    v_and_b32 v17, 0xffff0000, v76
    v_mul_f32 v89, v89, v17
    v_lshlrev_b32 v90, 16, v69
    v_lshlrev_b32 v17, 16, v77
    v_mul_f32 v90, v90, v17
    v_and_b32 v91, 0xffff0000, v69
    v_and_b32 v17, 0xffff0000, v77
    v_mul_f32 v91, v91, v17
    v_cvt_pk_bf16_f32 v17, v88, v89
    v_lshlrev_b32 v88, 16, v17
    v_and_b32 v89, 0xffff0000, v17
    v_cvt_pk_bf16_f32 v17, v90, v91
    v_lshlrev_b32 v90, 16, v17
    v_and_b32 v91, 0xffff0000, v17
    v_lshlrev_b32 v92, 16, v70
    v_lshlrev_b32 v17, 16, v78
    v_mul_f32 v92, v92, v17
    v_and_b32 v93, 0xffff0000, v70
    v_and_b32 v17, 0xffff0000, v78
    v_mul_f32 v93, v93, v17
    v_lshlrev_b32 v94, 16, v71
    v_lshlrev_b32 v17, 16, v79
    v_mul_f32 v94, v94, v17
    v_and_b32 v95, 0xffff0000, v71
    v_and_b32 v17, 0xffff0000, v79
    v_mul_f32 v95, v95, v17
    v_cvt_pk_bf16_f32 v17, v92, v93
    v_lshlrev_b32 v92, 16, v17
    v_and_b32 v93, 0xffff0000, v17
    v_cvt_pk_bf16_f32 v17, v94, v95
    v_lshlrev_b32 v94, 16, v17
    v_and_b32 v95, 0xffff0000, v17
    v_fma_f32 v80, v32, 2.0, v80
    v_fma_f32 v81, v33, 2.0, v81
    v_fma_f32 v82, v34, 2.0, v82
    v_fma_f32 v83, v35, 2.0, v83
    v_fma_f32 v84, v36, 2.0, v84
    v_fma_f32 v85, v37, 2.0, v85
    v_fma_f32 v86, v38, 2.0, v86
    v_fma_f32 v87, v39, 2.0, v87
    v_fma_f32 v88, v40, 2.0, v88
    v_fma_f32 v89, v41, 2.0, v89
    v_fma_f32 v90, v42, 2.0, v90
    v_fma_f32 v91, v43, 2.0, v91
    v_fma_f32 v92, v44, 2.0, v92
    v_fma_f32 v93, v45, 2.0, v93
    v_fma_f32 v94, v46, 2.0, v94
    v_fma_f32 v95, v47, 2.0, v95
    s_lshl_b32 s15, s12, 2
    v_mul_u32_u24 v6, 3584, v23
    v_lshl_add_u32 v6, v2, 4, v6
    buffer_store_dwordx4 v[80:83], v6, s[56:59], s15 offen offset:0
    buffer_store_dwordx4 v[84:87], v6, s[56:59], s15 offen offset:32
    buffer_store_dwordx4 v[88:91], v6, s[56:59], s15 offen offset:64
    buffer_store_dwordx4 v[92:95], v6, s[56:59], s15 offen offset:96
    s_endpgm
k3_o:
    s_add_u32 s44, s42, 0x1200000
    s_addc_u32 s45, s43, 0
    s_mov_b32 s46, 0x1c0000
    s_mov_b32 s47, 0x20000
    s_mov_b32 s48, s38
    s_mov_b32 s49, s39
    s_mov_b32 s50, 0x62000
    s_mov_b32 s51, 0x20000
    s_sub_u32 s7, s7, 7
    v_mul_u32_u24 v6, 896, v22
    v_add_u32 v14, v6, v12
    v_add_u32 v15, v6, v13
    v_add_u32 v15, 7168, v15
    s_lshl_b32 s13, s3, 3
    v_add_u32 v6, s13, v3
    v_mul_u32_u24 v6, 896, v6
    v_and_b32 v7, 1, v5
    v_lshlrev_b32 v7, 2, v7
    v_xor_b32 v7, v7, v4
    v_lshl_add_u32 v16, v7, 4, v6
    s_lshl_b32 s13, s7, 7
    v_add_u32 v16, s13, v16
    v_and_b32 v6, 15, v0
    v_lshrrev_b32 v7, 2, v6
    v_and_b32 v17, 3, v0
    v_lshlrev_b32 v17, 3, v17
    v_and_b32 v6, 1, v5
    v_lshl_add_u32 v17, v6, 5, v17
    s_lshl_b32 s14, s10, 6
    v_add_u32 v17, s14, v17
    v_lshrrev_b32 v6, 1, v7
    v_lshlrev_b32 v6, 6, v6
    v_xor_b32 v17, v17, v6
    v_lshrrev_b32 v6, 1, v5
    v_lshl_add_u32 v6, v6, 3, v7
    v_lshl_add_u32 v18, v6, 7, v17
    v_add_u32 v18, 98304, v18
    s_add_u32 m0, s74, 0
    s_mov_b32 s76, 0
    buffer_load_dwordx4 v14, s[44:47], s76 offen lds
    s_add_u32 m0, s74, 1024
    s_mov_b32 s76, 0
    buffer_load_dwordx4 v15, s[44:47], s76 offen lds
    s_add_u32 m0, s75, 0
    s_mov_b32 s76, 0
    buffer_load_dwordx4 v16, s[48:51], s76 offen lds
    s_add_u32 m0, s74, 16384
    s_mov_b32 s76, 128
    buffer_load_dwordx4 v14, s[44:47], s76 offen lds
    s_add_u32 m0, s74, 17408
    s_mov_b32 s76, 128
    buffer_load_dwordx4 v15, s[44:47], s76 offen lds
    s_add_u32 m0, s75, 8192
    s_mov_b32 s76, 57344
    buffer_load_dwordx4 v16, s[48:51], s76 offen lds
    s_add_u32 m0, s74, 32768
    s_mov_b32 s76, 256
    buffer_load_dwordx4 v14, s[44:47], s76 offen lds
    s_add_u32 m0, s74, 33792
    s_mov_b32 s76, 256
    buffer_load_dwordx4 v15, s[44:47], s76 offen lds
    s_add_u32 m0, s75, 16384
    s_mov_b32 s76, 114688
    buffer_load_dwordx4 v16, s[48:51], s76 offen lds
    s_add_u32 m0, s74, 49152
    s_mov_b32 s76, 384
    buffer_load_dwordx4 v14, s[44:47], s76 offen lds
    s_add_u32 m0, s74, 50176
    s_mov_b32 s76, 384
    buffer_load_dwordx4 v15, s[44:47], s76 offen lds
    s_add_u32 m0, s75, 24576
    s_mov_b32 s76, 172032
    buffer_load_dwordx4 v16, s[48:51], s76 offen lds
    s_add_u32 m0, s74, 65536
    s_mov_b32 s76, 512
    buffer_load_dwordx4 v14, s[44:47], s76 offen lds
    s_add_u32 m0, s74, 66560
    s_mov_b32 s76, 512
    buffer_load_dwordx4 v15, s[44:47], s76 offen lds
    s_add_u32 m0, s75, 32768
    s_mov_b32 s76, 229376
    buffer_load_dwordx4 v16, s[48:51], s76 offen lds
    s_waitcnt vmcnt(12) lgkmcnt(0)
    s_barrier
    ds_read_b128 v[96:99], v8 offset:0
    ds_read_b64_tr_b16 v[100:101], v18 offset:0
    ds_read_b64_tr_b16 v[102:103], v18 offset:512
    s_add_u32 m0, s74, 81920
    s_mov_b32 s76, 640
    buffer_load_dwordx4 v14, s[44:47], s76 offen lds
    ds_read_b128 v[104:107], v9 offset:0
    ds_read_b64_tr_b16 v[108:109], v18 offset:2048
    ds_read_b64_tr_b16 v[110:111], v18 offset:2560
    s_add_u32 m0, s74, 82944
    s_mov_b32 s76, 640
    buffer_load_dwordx4 v15, s[44:47], s76 offen lds
    ds_read_b128 v[112:115], v10 offset:0
    ds_read_b64_tr_b16 v[116:117], v18 offset:4096
    ds_read_b64_tr_b16 v[118:119], v18 offset:4608
    s_add_u32 m0, s75, 40960
    s_mov_b32 s76, 286720
    buffer_load_dwordx4 v16, s[48:51], s76 offen lds
    ds_read_b128 v[120:123], v11 offset:0
    ds_read_b64_tr_b16 v[124:125], v18 offset:6144
    ds_read_b64_tr_b16 v[126:127], v18 offset:6656
    s_waitcnt vmcnt(12) lgkmcnt(0)
    s_barrier
    ds_read_b128 v[128:131], v8 offset:16384
    ds_read_b64_tr_b16 v[132:133], v18 offset:8192
    ds_read_b64_tr_b16 v[134:135], v18 offset:8704
    v_mfma_f32_32x32x16_bf16 v[32:47], v[100:103], v[96:99], 0
    s_add_u32 m0, s74, 0
    s_mov_b32 s76, 768
    buffer_load_dwordx4 v14, s[44:47], s76 offen lds
    ds_read_b128 v[136:139], v9 offset:16384
    ds_read_b64_tr_b16 v[140:141], v18 offset:10240
    ds_read_b64_tr_b16 v[142:143], v18 offset:10752
    v_mfma_f32_32x32x16_bf16 v[32:47], v[108:111], v[104:107], v[32:47]
    s_add_u32 m0, s74, 1024
    s_mov_b32 s76, 768
    buffer_load_dwordx4 v15, s[44:47], s76 offen lds
    ds_read_b128 v[144:147], v10 offset:16384
    ds_read_b64_tr_b16 v[148:149], v18 offset:12288
    ds_read_b64_tr_b16 v[150:151], v18 offset:12800
    v_mfma_f32_32x32x16_bf16 v[32:47], v[116:119], v[112:115], v[32:47]
    s_add_u32 m0, s75, 0
    s_mov_b32 s76, 344064
    buffer_load_dwordx4 v16, s[48:51], s76 offen lds
    ds_read_b128 v[152:155], v11 offset:16384
    ds_read_b64_tr_b16 v[156:157], v18 offset:14336
    ds_read_b64_tr_b16 v[158:159], v18 offset:14848
    v_mfma_f32_32x32x16_bf16 v[32:47], v[124:127], v[120:123], v[32:47]
    s_waitcnt vmcnt(12) lgkmcnt(0)
    s_barrier
    ds_read_b128 v[96:99], v8 offset:32768
    ds_read_b64_tr_b16 v[100:101], v18 offset:16384
    ds_read_b64_tr_b16 v[102:103], v18 offset:16896
    v_mfma_f32_32x32x16_bf16 v[32:47], v[132:135], v[128:131], v[32:47]
    ds_read_b128 v[104:107], v9 offset:32768
    ds_read_b64_tr_b16 v[108:109], v18 offset:18432
    ds_read_b64_tr_b16 v[110:111], v18 offset:18944
    v_mfma_f32_32x32x16_bf16 v[32:47], v[140:143], v[136:139], v[32:47]
    ds_read_b128 v[112:115], v10 offset:32768
    ds_read_b64_tr_b16 v[116:117], v18 offset:20480
    ds_read_b64_tr_b16 v[118:119], v18 offset:20992
    v_mfma_f32_32x32x16_bf16 v[32:47], v[148:151], v[144:147], v[32:47]
    ds_read_b128 v[120:123], v11 offset:32768
    ds_read_b64_tr_b16 v[124:125], v18 offset:22528
    ds_read_b64_tr_b16 v[126:127], v18 offset:23040
    v_mfma_f32_32x32x16_bf16 v[32:47], v[156:159], v[152:155], v[32:47]
    s_waitcnt vmcnt(9) lgkmcnt(0)
    s_barrier
    ds_read_b128 v[128:131], v8 offset:49152
    ds_read_b64_tr_b16 v[132:133], v18 offset:24576
    ds_read_b64_tr_b16 v[134:135], v18 offset:25088
    v_mfma_f32_32x32x16_bf16 v[32:47], v[100:103], v[96:99], v[32:47]
    ds_read_b128 v[136:139], v9 offset:49152
    ds_read_b64_tr_b16 v[140:141], v18 offset:26624
    ds_read_b64_tr_b16 v[142:143], v18 offset:27136
    v_mfma_f32_32x32x16_bf16 v[32:47], v[108:111], v[104:107], v[32:47]
    ds_read_b128 v[144:147], v10 offset:49152
    ds_read_b64_tr_b16 v[148:149], v18 offset:28672
    ds_read_b64_tr_b16 v[150:151], v18 offset:29184
    v_mfma_f32_32x32x16_bf16 v[32:47], v[116:119], v[112:115], v[32:47]
    ds_read_b128 v[152:155], v11 offset:49152
    ds_read_b64_tr_b16 v[156:157], v18 offset:30720
    ds_read_b64_tr_b16 v[158:159], v18 offset:31232
    v_mfma_f32_32x32x16_bf16 v[32:47], v[124:127], v[120:123], v[32:47]
    s_waitcnt vmcnt(6) lgkmcnt(0)
    s_barrier
    ds_read_b128 v[96:99], v24 offset:0
    ds_read_b64_tr_b16 v[100:101], v18 offset:32768
    ds_read_b64_tr_b16 v[102:103], v18 offset:33280
    v_mfma_f32_32x32x16_bf16 v[32:47], v[132:135], v[128:131], v[32:47]
    ds_read_b128 v[104:107], v25 offset:0
    ds_read_b64_tr_b16 v[108:109], v18 offset:34816
    ds_read_b64_tr_b16 v[110:111], v18 offset:35328
    v_mfma_f32_32x32x16_bf16 v[32:47], v[140:143], v[136:139], v[32:47]
    ds_read_b128 v[112:115], v26 offset:0
    ds_read_b64_tr_b16 v[116:117], v18 offset:36864
    ds_read_b64_tr_b16 v[118:119], v18 offset:37376
    v_mfma_f32_32x32x16_bf16 v[32:47], v[148:151], v[144:147], v[32:47]
    ds_read_b128 v[120:123], v27 offset:0
    ds_read_b64_tr_b16 v[124:125], v18 offset:38912
    ds_read_b64_tr_b16 v[126:127], v18 offset:39424
    v_mfma_f32_32x32x16_bf16 v[32:47], v[156:159], v[152:155], v[32:47]
    s_waitcnt vmcnt(3) lgkmcnt(0)
    s_barrier
    ds_read_b128 v[128:131], v24 offset:16384
    ds_read_b64_tr_b16 v[132:133], v18 offset:40960
    ds_read_b64_tr_b16 v[134:135], v18 offset:41472
    v_mfma_f32_32x32x16_bf16 v[32:47], v[100:103], v[96:99], v[32:47]
    ds_read_b128 v[136:139], v25 offset:16384
    ds_read_b64_tr_b16 v[140:141], v18 offset:43008
    ds_read_b64_tr_b16 v[142:143], v18 offset:43520
    v_mfma_f32_32x32x16_bf16 v[32:47], v[108:111], v[104:107], v[32:47]
    ds_read_b128 v[144:147], v26 offset:16384
    ds_read_b64_tr_b16 v[148:149], v18 offset:45056
    ds_read_b64_tr_b16 v[150:151], v18 offset:45568
    v_mfma_f32_32x32x16_bf16 v[32:47], v[116:119], v[112:115], v[32:47]
    ds_read_b128 v[152:155], v27 offset:16384
    ds_read_b64_tr_b16 v[156:157], v18 offset:47104
    ds_read_b64_tr_b16 v[158:159], v18 offset:47616
    v_mfma_f32_32x32x16_bf16 v[32:47], v[124:127], v[120:123], v[32:47]
    s_waitcnt vmcnt(0) lgkmcnt(0)
    s_barrier
    ds_read_b128 v[96:99], v8 offset:0
    ds_read_b64_tr_b16 v[100:101], v18 offset:0
    ds_read_b64_tr_b16 v[102:103], v18 offset:512
    v_mfma_f32_32x32x16_bf16 v[32:47], v[132:135], v[128:131], v[32:47]
    ds_read_b128 v[104:107], v9 offset:0
    ds_read_b64_tr_b16 v[108:109], v18 offset:2048
    ds_read_b64_tr_b16 v[110:111], v18 offset:2560
    v_mfma_f32_32x32x16_bf16 v[32:47], v[140:143], v[136:139], v[32:47]
    ds_read_b128 v[112:115], v10 offset:0
    ds_read_b64_tr_b16 v[116:117], v18 offset:4096
    ds_read_b64_tr_b16 v[118:119], v18 offset:4608
    v_mfma_f32_32x32x16_bf16 v[32:47], v[148:151], v[144:147], v[32:47]
    ds_read_b128 v[120:123], v11 offset:0
    ds_read_b64_tr_b16 v[124:125], v18 offset:6144
    ds_read_b64_tr_b16 v[126:127], v18 offset:6656
    v_mfma_f32_32x32x16_bf16 v[32:47], v[156:159], v[152:155], v[32:47]
    s_waitcnt lgkmcnt(0)
    v_mfma_f32_32x32x16_bf16 v[32:47], v[100:103], v[96:99], v[32:47]
    v_mfma_f32_32x32x16_bf16 v[32:47], v[108:111], v[104:107], v[32:47]
    v_mfma_f32_32x32x16_bf16 v[32:47], v[116:119], v[112:115], v[32:47]
    v_mfma_f32_32x32x16_bf16 v[32:47], v[124:127], v[120:123], v[32:47]
    s_nop 15
    s_lshl_b32 s11, s7, 6
    s_lshl_b32 s12, s10, 5
    s_add_u32 s12, s12, s11
    s_lshl_b32 s15, s12, 2
    s_add_u32 s15, s15, 1792
    v_mul_u32_u24 v6, 3584, v23
    v_lshl_add_u32 v6, v2, 4, v6
    v_cvt_pk_bf16_f32 v17, v32, v33
    v_lshlrev_b32 v80, 16, v17
    v_and_b32 v81, 0xffff0000, v17
    v_cvt_pk_bf16_f32 v17, v34, v35
    v_lshlrev_b32 v82, 16, v17
    v_and_b32 v83, 0xffff0000, v17
    v_cvt_pk_bf16_f32 v17, v36, v37
    v_lshlrev_b32 v84, 16, v17
    v_and_b32 v85, 0xffff0000, v17
    v_cvt_pk_bf16_f32 v17, v38, v39
    v_lshlrev_b32 v86, 16, v17
    v_and_b32 v87, 0xffff0000, v17
    v_cvt_pk_bf16_f32 v17, v40, v41
    v_lshlrev_b32 v88, 16, v17
    v_and_b32 v89, 0xffff0000, v17
    v_cvt_pk_bf16_f32 v17, v42, v43
    v_lshlrev_b32 v90, 16, v17
    v_and_b32 v91, 0xffff0000, v17
    v_cvt_pk_bf16_f32 v17, v44, v45
    v_lshlrev_b32 v92, 16, v17
    v_and_b32 v93, 0xffff0000, v17
    v_cvt_pk_bf16_f32 v17, v46, v47
    v_lshlrev_b32 v94, 16, v17
    v_and_b32 v95, 0xffff0000, v17
    buffer_store_dwordx4 v[80:83], v6, s[56:59], s15 offen offset:0
    buffer_store_dwordx4 v[84:87], v6, s[56:59], s15 offen offset:32
    buffer_store_dwordx4 v[88:91], v6, s[56:59], s15 offen offset:64
    buffer_store_dwordx4 v[92:95], v6, s[56:59], s15 offen offset:96
k3_exit:
    s_endpgm
.section .rodata,"a"
.p2align 6
.amdhsa_kernel k1_kernel
  .amdhsa_next_free_vgpr 226
  .amdhsa_next_free_sgpr 96
  .amdhsa_accum_offset 228
  .amdhsa_group_segment_fixed_size 0
  .amdhsa_kernarg_size 120
  .amdhsa_user_sgpr_count 2
  .amdhsa_user_sgpr_kernarg_segment_ptr 1
  .amdhsa_system_sgpr_workgroup_id_x 1
.end_amdhsa_kernel
.p2align 6
.amdhsa_kernel k2_kernel
  .amdhsa_next_free_vgpr 254
  .amdhsa_next_free_sgpr 96
  .amdhsa_accum_offset 256
  .amdhsa_group_segment_fixed_size 0
  .amdhsa_kernarg_size 120
  .amdhsa_user_sgpr_count 2
  .amdhsa_user_sgpr_kernarg_segment_ptr 1
  .amdhsa_system_sgpr_workgroup_id_x 1
.end_amdhsa_kernel
.p2align 6
.amdhsa_kernel k3_kernel
  .amdhsa_next_free_vgpr 160
  .amdhsa_next_free_sgpr 96
  .amdhsa_accum_offset 160
  .amdhsa_group_segment_fixed_size 0
  .amdhsa_kernarg_size 120
  .amdhsa_user_sgpr_count 2
  .amdhsa_user_sgpr_kernarg_segment_ptr 1
  .amdhsa_system_sgpr_workgroup_id_x 1
.end_amdhsa_kernel
```
